```python
import torch

def _softmax(x, axis=-1):
    return torch.softmax(x, dim=axis)
def _gelu(x):
    return torch.nn.functional.gelu(x, approximate="tanh")
def _silu(x):
    return torch.nn.functional.silu(x)
def _sigmoid(x):
    return torch.sigmoid(x)
def _layernorm(x, axis=-1, eps=1e-5):
    m = x.mean(dim=axis, keepdim=True)
    v = x.var(dim=axis, keepdim=True, unbiased=False)
    return (x - m) / torch.sqrt(v + eps)
def _scatter_add(tgt, idx, src, axis=0):
    return tgt.clone().index_add_(axis, idx, src)
def _segment_sum(src, seg, n):
    out = torch.zeros((n,) + src.shape[1:], dtype=src.dtype)
    return out.index_add_(0, seg, src)
def _pad(x, pw):
    flat = tuple(v for pair in reversed(pw) for v in pair)
    return torch.nn.functional.pad(x, flat)

kernel_name = 'sequential_preLN__mha_block_cached__geglu_ffn__decode'

def setup_inputs():

    _w = (lambda a: (lambda t: t.to(torch.bfloat16) if t.is_floating_point() else t)(torch.as_tensor(a)))
    def _A_setup():
        B, Sq, D = 1, 1, 512
        H, Sk, Dh = 32, 16384, 128
        return {
            "x": _w((lambda *s: torch.randn(*s, dtype=torch.bfloat16) * 0.05)(B, Sq, D)),
            "k_cache": _w((lambda *s: torch.randn(*s, dtype=torch.bfloat16) * 3.2)(B, H, Sk, Dh)),
            "v_cache": _w((lambda *s: torch.randn(*s, dtype=torch.bfloat16) * 0.4)(B, H, Sk, Dh)),
            "wq": _w((lambda *s: torch.randn(*s, dtype=torch.bfloat16) * 3.2)(D, H * Dh) * (D ** -0.5)),
            "wo": _w((lambda *s: torch.randn(*s, dtype=torch.bfloat16) * 0.4)(H * Dh, D) * ((H * Dh) ** -0.5)),
        }
    _A_in = _A_setup()

    def _B_setup():
        B, S, D, F = 1, 1, 512, 1792
        return {
            "x": _w((lambda *s: torch.randn(*s, dtype=torch.bfloat16) * 0.05)(B, S, D)),
            "w_gate": _w((lambda *s: torch.randn(*s, dtype=torch.bfloat16) * 0.05)(D, F)),
            "w_up": _w((lambda *s: torch.randn(*s, dtype=torch.bfloat16) * 0.05)(D, F)),
            "w_down": _w((lambda *s: torch.randn(*s, dtype=torch.bfloat16) * 0.05)(F, D)),
        }
    _B_in = _B_setup()

    return {
        "A_x": _A_in["x"],
        "A_k_cache": _A_in["k_cache"],
        "A_v_cache": _A_in["v_cache"],
        "A_wq": _A_in["wq"],
        "A_wo": _A_in["wo"],
        "B_x": _B_in["x"],
        "B_w_gate": _B_in["w_gate"],
        "B_w_up": _B_in["w_up"],
        "B_w_down": _B_in["w_down"],
    }

def reference(A_x, A_k_cache, A_v_cache, A_wq, A_wo, B_x, B_w_gate, B_w_up, B_w_down):
    def _A_ref(x, k_cache, v_cache, wq, wo):
        B, Sq, D = x.shape
        H, Dh = 32, 128
        q = (lambda x, *d: x.permute(*d))((x @ wq).reshape(B, Sq, H, Dh), 0, 2, 1, 3)
        scores = torch.einsum("bhqd,bhkd->bhqk", q, k_cache) * (Dh ** -0.5)
        p = _softmax(scores, axis=-1)
        o = torch.einsum("bhqk,bhkd->bhqd", p, v_cache)
        return (lambda x, *d: x.permute(*d))(o, 0, 2, 1, 3).reshape(B, Sq, H * Dh) @ wo

    def _B_ref(x, w_gate, w_up, w_down):
        return (_gelu(x @ w_gate) * (x @ w_up)) @ w_down

    x = A_x
    h = x + _A_ref(_layernorm(x, axis=-1), A_k_cache, A_v_cache, A_wq, A_wo)
    h2 = h + _B_ref(_layernorm(h, axis=-1), B_w_gate, B_w_up, B_w_down)
    return h2
```

```asm
; @launch kernel=attn_kernel grid=(256,1,1) block=(1024,1,1) lds=36864
; @launch kernel=wo_kernel grid=(256,1,1) block=(256,1,1) lds=4608
; @launch kernel=geglu_kernel grid=(224,1,1) block=(256,1,1) lds=10304
; @launch kernel=down_kernel grid=(256,1,1) block=(64,1,1) lds=1280
; @launch kernel=final_kernel grid=(8,1,1) block=(64,1,1) lds=0
.amdgcn_target "amdgcn-amd-amdhsa--gfx950"
.text
.globl attn_kernel
.p2align 8
.type attn_kernel,@function
attn_kernel:
    s_cmp_ge_u32 s2, 256
    s_cbranch_scc1 A_done
    s_load_dwordx4 s[4:7], s[0:1], 0
    s_load_dwordx4 s[8:11], s[0:1], 16
    s_load_dwordx2 s[12:13], s[0:1], 88
    v_and_b32 v2, 63, v0
    v_lshrrev_b32 v3, 6, v0
    s_nop 0
    v_readfirstlane_b32 s14, v3
    s_and_b32 s15, s2, 31
    s_lshr_b32 s3, s2, 5
    v_lshlrev_b32 v1, 4, v2
    s_mov_b32 s39, 0x3fb8aa3b
    s_waitcnt lgkmcnt(0)
    s_mov_b32 s16, s4
    s_mov_b32 s17, s5
    s_mov_b32 s18, 1024
    s_mov_b32 s19, 0x00020000
    s_lshl_b32 s38, s15, 8
    s_add_u32 s20, s10, s38
    s_addc_u32 s21, s11, 0
    s_sub_u32 s22, 4194304, s38
    s_mov_b32 s23, 0x00020000
    s_lshl_b32 s38, s15, 22
    s_lshl_b32 s36, s3, 19
    s_add_u32 s38, s38, s36
    s_lshl_b32 s36, s14, 15
    s_add_u32 s38, s38, s36
    s_add_u32 s24, s6, s38
    s_addc_u32 s25, s7, 0
    s_mov_b32 s26, 32768
    s_mov_b32 s27, 0x00020000
    s_add_u32 s28, s8, s38
    s_addc_u32 s29, s9, 0
    s_mov_b32 s30, 32768
    s_mov_b32 s31, 0x00020000
    s_lshl_b32 s38, s15, 3
    s_add_u32 s38, s38, s3
    s_lshl_b32 s38, s38, 10
    s_add_u32 s38, s38, 0
    s_add_u32 s32, s12, s38
    s_addc_u32 s33, s13, 0
    s_mov_b32 s34, 1024
    s_mov_b32 s35, 0x00020000
    buffer_load_dwordx4 v[4:7], v1, s[16:19], 0 offen
    v_lshrrev_b32 v3, 4, v2
    v_lshlrev_b32 v3, 13, v3
    v_and_b32 v26, 15, v2
    v_lshl_add_u32 v3, v26, 4, v3
    s_lshl_b32 s36, s14, 18
    buffer_load_dwordx4 v[28:31], v3, s[20:23], s36 offen
    s_add_u32 s36, s36, 0x8000
    buffer_load_dwordx4 v[32:35], v3, s[20:23], s36 offen
    s_add_u32 s36, s36, 0x8000
    buffer_load_dwordx4 v[36:39], v3, s[20:23], s36 offen
    s_add_u32 s36, s36, 0x8000
    buffer_load_dwordx4 v[40:43], v3, s[20:23], s36 offen
    s_add_u32 s36, s36, 0x8000
    buffer_load_dwordx4 v[44:47], v3, s[20:23], s36 offen
    s_add_u32 s36, s36, 0x8000
    buffer_load_dwordx4 v[48:51], v3, s[20:23], s36 offen
    s_add_u32 s36, s36, 0x8000
    buffer_load_dwordx4 v[52:55], v3, s[20:23], s36 offen
    s_add_u32 s36, s36, 0x8000
    buffer_load_dwordx4 v[56:59], v3, s[20:23], s36 offen
    s_mov_b32 s36, 0
    buffer_load_dwordx4 v[60:63], v1, s[24:27], s36 offen offset:0 nt
    buffer_load_dwordx4 v[64:67], v1, s[24:27], s36 offen offset:1024 nt
    buffer_load_dwordx4 v[68:71], v1, s[24:27], s36 offen offset:2048 nt
    buffer_load_dwordx4 v[72:75], v1, s[24:27], s36 offen offset:3072 nt
    s_mov_b32 s36, 4096
    buffer_load_dwordx4 v[76:79], v1, s[24:27], s36 offen offset:0 nt
    buffer_load_dwordx4 v[80:83], v1, s[24:27], s36 offen offset:1024 nt
    buffer_load_dwordx4 v[84:87], v1, s[24:27], s36 offen offset:2048 nt
    buffer_load_dwordx4 v[88:91], v1, s[24:27], s36 offen offset:3072 nt
    s_mov_b32 s36, 8192
    buffer_load_dwordx4 v[92:95], v1, s[24:27], s36 offen offset:0 nt
    buffer_load_dwordx4 v[96:99], v1, s[24:27], s36 offen offset:1024 nt
    buffer_load_dwordx4 v[100:103], v1, s[24:27], s36 offen offset:2048 nt
    buffer_load_dwordx4 v[104:107], v1, s[24:27], s36 offen offset:3072 nt
    s_mov_b32 s36, 12288
    buffer_load_dwordx4 v[108:111], v1, s[24:27], s36 offen offset:0 nt
    buffer_load_dwordx4 v[112:115], v1, s[24:27], s36 offen offset:1024 nt
    buffer_load_dwordx4 v[116:119], v1, s[24:27], s36 offen offset:2048 nt
    buffer_load_dwordx4 v[120:123], v1, s[24:27], s36 offen offset:3072 nt
    s_waitcnt vmcnt(24)
    v_lshlrev_b32 v16, 16, v4
    v_and_b32 v17, 0xffff0000, v4
    v_lshlrev_b32 v18, 16, v5
    v_and_b32 v19, 0xffff0000, v5
    v_lshlrev_b32 v20, 16, v6
    v_and_b32 v21, 0xffff0000, v6
    v_lshlrev_b32 v22, 16, v7
    v_and_b32 v23, 0xffff0000, v7
    v_add_f32 v3, v16, v17
    v_add_f32 v26, v18, v19
    v_add_f32 v27, v20, v21
    v_add_f32 v24, v22, v23
    v_add_f32 v3, v3, v26
    v_add_f32 v27, v27, v24
    v_add_f32 v3, v3, v27
    s_nop 1
    v_add_f32_dpp v3, v3, v3 row_ror:8 row_mask:0xf bank_mask:0xf
    s_nop 1
    v_add_f32_dpp v3, v3, v3 row_ror:4 row_mask:0xf bank_mask:0xf
    s_nop 1
    v_add_f32_dpp v3, v3, v3 row_ror:2 row_mask:0xf bank_mask:0xf
    s_nop 1
    v_add_f32_dpp v3, v3, v3 row_ror:1 row_mask:0xf bank_mask:0xf
    s_nop 0
    v_readlane_b32 s40, v3, 0
    v_readlane_b32 s41, v3, 16
    v_readlane_b32 s42, v3, 32
    v_readlane_b32 s43, v3, 48
    s_nop 1
    v_mov_b32 v3, s40
    v_add_f32 v3, s41, v3
    v_add_f32 v3, s42, v3
    v_add_f32 v3, s43, v3
    v_mul_f32 v24, 0x3b000000, v3
    v_sub_f32 v4, v16, v24
    v_sub_f32 v5, v17, v24
    v_sub_f32 v6, v18, v24
    v_sub_f32 v7, v19, v24
    v_sub_f32 v8, v20, v24
    v_sub_f32 v9, v21, v24
    v_sub_f32 v10, v22, v24
    v_sub_f32 v11, v23, v24
    v_mul_f32 v3, v4, v4
    v_fmac_f32 v3, v5, v5
    v_fmac_f32 v3, v6, v6
    v_fmac_f32 v3, v7, v7
    v_fmac_f32 v3, v8, v8
    v_fmac_f32 v3, v9, v9
    v_fmac_f32 v3, v10, v10
    v_fmac_f32 v3, v11, v11
    s_nop 1
    v_add_f32_dpp v3, v3, v3 row_ror:8 row_mask:0xf bank_mask:0xf
    s_nop 1
    v_add_f32_dpp v3, v3, v3 row_ror:4 row_mask:0xf bank_mask:0xf
    s_nop 1
    v_add_f32_dpp v3, v3, v3 row_ror:2 row_mask:0xf bank_mask:0xf
    s_nop 1
    v_add_f32_dpp v3, v3, v3 row_ror:1 row_mask:0xf bank_mask:0xf
    s_nop 0
    v_readlane_b32 s40, v3, 0
    v_readlane_b32 s41, v3, 16
    v_readlane_b32 s42, v3, 32
    v_readlane_b32 s43, v3, 48
    s_nop 1
    v_mov_b32 v3, s40
    v_add_f32 v3, s41, v3
    v_add_f32 v3, s42, v3
    v_add_f32 v3, s43, v3
    v_mul_f32 v3, 0x3b000000, v3
    v_cvt_pk_bf16_f32 v26, v24, v24
    v_lshlrev_b32 v24, 16, v26
    v_cvt_pk_bf16_f32 v26, v3, v3
    v_lshlrev_b32 v3, 16, v26
    v_add_f32 v3, 0x3727c5ac, v3
    v_cvt_pk_bf16_f32 v26, v3, v3
    v_lshlrev_b32 v3, 16, v26
    v_sqrt_f32 v26, v3
    s_nop 0
    v_fma_f32 v27, -v26, v26, v3
    v_rcp_f32 v25, v26
    s_nop 0
    v_mul_f32 v25, 0.5, v25
    v_fma_f32 v26, v27, v25, v26
    v_cvt_pk_bf16_f32 v27, v26, v26
    v_lshlrev_b32 v26, 16, v27
    v_rcp_f32 v25, v26
    v_sub_f32 v4, v16, v24
    v_sub_f32 v5, v17, v24
    v_sub_f32 v6, v18, v24
    v_sub_f32 v7, v19, v24
    v_sub_f32 v8, v20, v24
    v_sub_f32 v9, v21, v24
    v_sub_f32 v10, v22, v24
    v_sub_f32 v11, v23, v24
    v_cvt_pk_bf16_f32 v27, v4, v4
    v_lshlrev_b32 v4, 16, v27
    v_cvt_pk_bf16_f32 v27, v5, v5
    v_lshlrev_b32 v5, 16, v27
    v_cvt_pk_bf16_f32 v27, v6, v6
    v_lshlrev_b32 v6, 16, v27
    v_cvt_pk_bf16_f32 v27, v7, v7
    v_lshlrev_b32 v7, 16, v27
    v_cvt_pk_bf16_f32 v27, v8, v8
    v_lshlrev_b32 v8, 16, v27
    v_cvt_pk_bf16_f32 v27, v9, v9
    v_lshlrev_b32 v9, 16, v27
    v_cvt_pk_bf16_f32 v27, v10, v10
    v_lshlrev_b32 v10, 16, v27
    v_cvt_pk_bf16_f32 v27, v11, v11
    v_lshlrev_b32 v11, 16, v27
    v_mul_f32 v16, v4, v25
    v_fma_f32 v27, -v16, v26, v4
    v_fma_f32 v16, v27, v25, v16
    v_cvt_pk_bf16_f32 v27, v16, v16
    v_lshlrev_b32 v16, 16, v27
    v_mul_f32 v17, v5, v25
    v_fma_f32 v27, -v17, v26, v5
    v_fma_f32 v17, v27, v25, v17
    v_cvt_pk_bf16_f32 v27, v17, v17
    v_lshlrev_b32 v17, 16, v27
    v_mul_f32 v18, v6, v25
    v_fma_f32 v27, -v18, v26, v6
    v_fma_f32 v18, v27, v25, v18
    v_cvt_pk_bf16_f32 v27, v18, v18
    v_lshlrev_b32 v18, 16, v27
    v_mul_f32 v19, v7, v25
    v_fma_f32 v27, -v19, v26, v7
    v_fma_f32 v19, v27, v25, v19
    v_cvt_pk_bf16_f32 v27, v19, v19
    v_lshlrev_b32 v19, 16, v27
    v_mul_f32 v20, v8, v25
    v_fma_f32 v27, -v20, v26, v8
    v_fma_f32 v20, v27, v25, v20
    v_cvt_pk_bf16_f32 v27, v20, v20
    v_lshlrev_b32 v20, 16, v27
    v_mul_f32 v21, v9, v25
    v_fma_f32 v27, -v21, v26, v9
    v_fma_f32 v21, v27, v25, v21
    v_cvt_pk_bf16_f32 v27, v21, v21
    v_lshlrev_b32 v21, 16, v27
    v_mul_f32 v22, v10, v25
    v_fma_f32 v27, -v22, v26, v10
    v_fma_f32 v22, v27, v25, v22
    v_cvt_pk_bf16_f32 v27, v22, v22
    v_lshlrev_b32 v22, 16, v27
    v_mul_f32 v23, v11, v25
    v_fma_f32 v27, -v23, v26, v11
    v_fma_f32 v23, v27, v25, v23
    v_cvt_pk_bf16_f32 v27, v23, v23
    v_lshlrev_b32 v23, 16, v27
    v_lshlrev_b32 v3, 5, v2
    ds_write_b128 v3, v[16:19] offset:0
    ds_write_b128 v3, v[20:23] offset:16
    v_lshrrev_b32 v26, 4, v2
    v_lshlrev_b32 v26, 2, v26
    s_lshl_b32 s38, s14, 7
    v_add_u32 v26, s38, v26
    s_waitcnt lgkmcnt(0)
    ds_read_b32 v4, v26 offset:0
    ds_read_b32 v5, v26 offset:16
    ds_read_b32 v6, v26 offset:32
    ds_read_b32 v7, v26 offset:48
    ds_read_b32 v8, v26 offset:64
    ds_read_b32 v9, v26 offset:80
    ds_read_b32 v10, v26 offset:96
    ds_read_b32 v11, v26 offset:112
    s_waitcnt vmcnt(16) lgkmcnt(0)
    v_lshlrev_b32 v26, 16, v28
    v_and_b32 v27, 0xffff0000, v28
    v_mul_f32 v16, v4, v26
    v_mul_f32 v17, v4, v27
    v_lshlrev_b32 v26, 16, v29
    v_and_b32 v27, 0xffff0000, v29
    v_mul_f32 v18, v4, v26
    v_mul_f32 v19, v4, v27
    v_lshlrev_b32 v26, 16, v30
    v_and_b32 v27, 0xffff0000, v30
    v_mul_f32 v20, v4, v26
    v_mul_f32 v21, v4, v27
    v_lshlrev_b32 v26, 16, v31
    v_and_b32 v27, 0xffff0000, v31
    v_mul_f32 v22, v4, v26
    v_mul_f32 v23, v4, v27
    v_lshlrev_b32 v26, 16, v32
    v_and_b32 v27, 0xffff0000, v32
    v_fmac_f32 v16, v5, v26
    v_fmac_f32 v17, v5, v27
    v_lshlrev_b32 v26, 16, v33
    v_and_b32 v27, 0xffff0000, v33
    v_fmac_f32 v18, v5, v26
    v_fmac_f32 v19, v5, v27
    v_lshlrev_b32 v26, 16, v34
    v_and_b32 v27, 0xffff0000, v34
    v_fmac_f32 v20, v5, v26
    v_fmac_f32 v21, v5, v27
    v_lshlrev_b32 v26, 16, v35
    v_and_b32 v27, 0xffff0000, v35
    v_fmac_f32 v22, v5, v26
    v_fmac_f32 v23, v5, v27
    v_lshlrev_b32 v26, 16, v36
    v_and_b32 v27, 0xffff0000, v36
    v_fmac_f32 v16, v6, v26
    v_fmac_f32 v17, v6, v27
    v_lshlrev_b32 v26, 16, v37
    v_and_b32 v27, 0xffff0000, v37
    v_fmac_f32 v18, v6, v26
    v_fmac_f32 v19, v6, v27
    v_lshlrev_b32 v26, 16, v38
    v_and_b32 v27, 0xffff0000, v38
    v_fmac_f32 v20, v6, v26
    v_fmac_f32 v21, v6, v27
    v_lshlrev_b32 v26, 16, v39
    v_and_b32 v27, 0xffff0000, v39
    v_fmac_f32 v22, v6, v26
    v_fmac_f32 v23, v6, v27
    v_lshlrev_b32 v26, 16, v40
    v_and_b32 v27, 0xffff0000, v40
    v_fmac_f32 v16, v7, v26
    v_fmac_f32 v17, v7, v27
    v_lshlrev_b32 v26, 16, v41
    v_and_b32 v27, 0xffff0000, v41
    v_fmac_f32 v18, v7, v26
    v_fmac_f32 v19, v7, v27
    v_lshlrev_b32 v26, 16, v42
    v_and_b32 v27, 0xffff0000, v42
    v_fmac_f32 v20, v7, v26
    v_fmac_f32 v21, v7, v27
    v_lshlrev_b32 v26, 16, v43
    v_and_b32 v27, 0xffff0000, v43
    v_fmac_f32 v22, v7, v26
    v_fmac_f32 v23, v7, v27
    v_lshlrev_b32 v26, 16, v44
    v_and_b32 v27, 0xffff0000, v44
    v_fmac_f32 v16, v8, v26
    v_fmac_f32 v17, v8, v27
    v_lshlrev_b32 v26, 16, v45
    v_and_b32 v27, 0xffff0000, v45
    v_fmac_f32 v18, v8, v26
    v_fmac_f32 v19, v8, v27
    v_lshlrev_b32 v26, 16, v46
    v_and_b32 v27, 0xffff0000, v46
    v_fmac_f32 v20, v8, v26
    v_fmac_f32 v21, v8, v27
    v_lshlrev_b32 v26, 16, v47
    v_and_b32 v27, 0xffff0000, v47
    v_fmac_f32 v22, v8, v26
    v_fmac_f32 v23, v8, v27
    v_lshlrev_b32 v26, 16, v48
    v_and_b32 v27, 0xffff0000, v48
    v_fmac_f32 v16, v9, v26
    v_fmac_f32 v17, v9, v27
    v_lshlrev_b32 v26, 16, v49
    v_and_b32 v27, 0xffff0000, v49
    v_fmac_f32 v18, v9, v26
    v_fmac_f32 v19, v9, v27
    v_lshlrev_b32 v26, 16, v50
    v_and_b32 v27, 0xffff0000, v50
    v_fmac_f32 v20, v9, v26
    v_fmac_f32 v21, v9, v27
    v_lshlrev_b32 v26, 16, v51
    v_and_b32 v27, 0xffff0000, v51
    v_fmac_f32 v22, v9, v26
    v_fmac_f32 v23, v9, v27
    v_lshlrev_b32 v26, 16, v52
    v_and_b32 v27, 0xffff0000, v52
    v_fmac_f32 v16, v10, v26
    v_fmac_f32 v17, v10, v27
    v_lshlrev_b32 v26, 16, v53
    v_and_b32 v27, 0xffff0000, v53
    v_fmac_f32 v18, v10, v26
    v_fmac_f32 v19, v10, v27
    v_lshlrev_b32 v26, 16, v54
    v_and_b32 v27, 0xffff0000, v54
    v_fmac_f32 v20, v10, v26
    v_fmac_f32 v21, v10, v27
    v_lshlrev_b32 v26, 16, v55
    v_and_b32 v27, 0xffff0000, v55
    v_fmac_f32 v22, v10, v26
    v_fmac_f32 v23, v10, v27
    v_lshlrev_b32 v26, 16, v56
    v_and_b32 v27, 0xffff0000, v56
    v_fmac_f32 v16, v11, v26
    v_fmac_f32 v17, v11, v27
    v_lshlrev_b32 v26, 16, v57
    v_and_b32 v27, 0xffff0000, v57
    v_fmac_f32 v18, v11, v26
    v_fmac_f32 v19, v11, v27
    v_lshlrev_b32 v26, 16, v58
    v_and_b32 v27, 0xffff0000, v58
    v_fmac_f32 v20, v11, v26
    v_fmac_f32 v21, v11, v27
    v_lshlrev_b32 v26, 16, v59
    v_and_b32 v27, 0xffff0000, v59
    v_fmac_f32 v22, v11, v26
    v_fmac_f32 v23, v11, v27
    s_lshl_b32 s38, s14, 11
    v_add_u32 v3, s38, v3
    ds_write_b128 v3, v[16:19] offset:4096
    ds_write_b128 v3, v[20:23] offset:4112
    s_waitcnt lgkmcnt(0)
    s_barrier
    s_cmp_ge_u32 s14, 2
    s_cbranch_scc1 A_qdone
    v_lshlrev_b32 v3, 2, v0
    ds_read_b32 v28, v3 offset:4096
    ds_read_b32 v29, v3 offset:4608
    ds_read_b32 v30, v3 offset:5120
    ds_read_b32 v31, v3 offset:5632
    ds_read_b32 v32, v3 offset:6144
    ds_read_b32 v33, v3 offset:6656
    ds_read_b32 v34, v3 offset:7168
    ds_read_b32 v35, v3 offset:7680
    ds_read_b32 v36, v3 offset:8192
    ds_read_b32 v37, v3 offset:8704
    ds_read_b32 v38, v3 offset:9216
    ds_read_b32 v39, v3 offset:9728
    ds_read_b32 v40, v3 offset:10240
    ds_read_b32 v41, v3 offset:10752
    ds_read_b32 v42, v3 offset:11264
    ds_read_b32 v43, v3 offset:11776
    ds_read_b32 v44, v3 offset:12288
    ds_read_b32 v45, v3 offset:12800
    ds_read_b32 v46, v3 offset:13312
    ds_read_b32 v47, v3 offset:13824
    ds_read_b32 v48, v3 offset:14336
    ds_read_b32 v49, v3 offset:14848
    ds_read_b32 v50, v3 offset:15360
    ds_read_b32 v51, v3 offset:15872
    ds_read_b32 v52, v3 offset:16384
    ds_read_b32 v53, v3 offset:16896
    ds_read_b32 v54, v3 offset:17408
    ds_read_b32 v55, v3 offset:17920
    ds_read_b32 v56, v3 offset:18432
    ds_read_b32 v57, v3 offset:18944
    ds_read_b32 v58, v3 offset:19456
    ds_read_b32 v59, v3 offset:19968
    s_waitcnt lgkmcnt(0)
    v_add_f32 v26, v28, v29
    v_add_f32 v26, v26, v30
    v_add_f32 v26, v26, v31
    v_add_f32 v26, v26, v32
    v_add_f32 v26, v26, v33
    v_add_f32 v26, v26, v34
    v_add_f32 v26, v26, v35
    v_add_f32 v26, v26, v36
    v_add_f32 v26, v26, v37
    v_add_f32 v26, v26, v38
    v_add_f32 v26, v26, v39
    v_add_f32 v26, v26, v40
    v_add_f32 v26, v26, v41
    v_add_f32 v26, v26, v42
    v_add_f32 v26, v26, v43
    v_add_f32 v26, v26, v44
    v_add_f32 v26, v26, v45
    v_add_f32 v26, v26, v46
    v_add_f32 v26, v26, v47
    v_add_f32 v26, v26, v48
    v_add_f32 v26, v26, v49
    v_add_f32 v26, v26, v50
    v_add_f32 v26, v26, v51
    v_add_f32 v26, v26, v52
    v_add_f32 v26, v26, v53
    v_add_f32 v26, v26, v54
    v_add_f32 v26, v26, v55
    v_add_f32 v26, v26, v56
    v_add_f32 v26, v26, v57
    v_add_f32 v26, v26, v58
    v_add_f32 v26, v26, v59
    ds_read_b32 v28, v3 offset:20480
    ds_read_b32 v29, v3 offset:20992
    ds_read_b32 v30, v3 offset:21504
    ds_read_b32 v31, v3 offset:22016
    ds_read_b32 v32, v3 offset:22528
    ds_read_b32 v33, v3 offset:23040
    ds_read_b32 v34, v3 offset:23552
    ds_read_b32 v35, v3 offset:24064
    ds_read_b32 v36, v3 offset:24576
    ds_read_b32 v37, v3 offset:25088
    ds_read_b32 v38, v3 offset:25600
    ds_read_b32 v39, v3 offset:26112
    ds_read_b32 v40, v3 offset:26624
    ds_read_b32 v41, v3 offset:27136
    ds_read_b32 v42, v3 offset:27648
    ds_read_b32 v43, v3 offset:28160
    ds_read_b32 v44, v3 offset:28672
    ds_read_b32 v45, v3 offset:29184
    ds_read_b32 v46, v3 offset:29696
    ds_read_b32 v47, v3 offset:30208
    ds_read_b32 v48, v3 offset:30720
    ds_read_b32 v49, v3 offset:31232
    ds_read_b32 v50, v3 offset:31744
    ds_read_b32 v51, v3 offset:32256
    ds_read_b32 v52, v3 offset:32768
    ds_read_b32 v53, v3 offset:33280
    ds_read_b32 v54, v3 offset:33792
    ds_read_b32 v55, v3 offset:34304
    ds_read_b32 v56, v3 offset:34816
    ds_read_b32 v57, v3 offset:35328
    ds_read_b32 v58, v3 offset:35840
    ds_read_b32 v59, v3 offset:36352
    s_waitcnt lgkmcnt(0)
    v_add_f32 v26, v26, v28
    v_add_f32 v26, v26, v29
    v_add_f32 v26, v26, v30
    v_add_f32 v26, v26, v31
    v_add_f32 v26, v26, v32
    v_add_f32 v26, v26, v33
    v_add_f32 v26, v26, v34
    v_add_f32 v26, v26, v35
    v_add_f32 v26, v26, v36
    v_add_f32 v26, v26, v37
    v_add_f32 v26, v26, v38
    v_add_f32 v26, v26, v39
    v_add_f32 v26, v26, v40
    v_add_f32 v26, v26, v41
    v_add_f32 v26, v26, v42
    v_add_f32 v26, v26, v43
    v_add_f32 v26, v26, v44
    v_add_f32 v26, v26, v45
    v_add_f32 v26, v26, v46
    v_add_f32 v26, v26, v47
    v_add_f32 v26, v26, v48
    v_add_f32 v26, v26, v49
    v_add_f32 v26, v26, v50
    v_add_f32 v26, v26, v51
    v_add_f32 v26, v26, v52
    v_add_f32 v26, v26, v53
    v_add_f32 v26, v26, v54
    v_add_f32 v26, v26, v55
    v_add_f32 v26, v26, v56
    v_add_f32 v26, v26, v57
    v_add_f32 v26, v26, v58
    v_add_f32 v26, v26, v59
    v_cvt_pk_bf16_f32 v26, v26, v26
    v_lshlrev_b32 v27, 1, v0
    ds_write_b16 v27, v26 offset:2048
    s_waitcnt lgkmcnt(0)
A_qdone:
    s_barrier
    v_and_b32 v3, 15, v2
    v_lshlrev_b32 v3, 4, v3
    ds_read_b128 v[12:15], v3 offset:2048
    s_waitcnt lgkmcnt(0)
    s_waitcnt vmcnt(12)
    v_dot2_f32_bf16 v28, v60, v12, 0
    v_dot2_f32_bf16 v29, v64, v12, 0
    v_dot2_f32_bf16 v30, v68, v12, 0
    v_dot2_f32_bf16 v31, v72, v12, 0
    v_dot2_f32_bf16 v28, v61, v13, v28
    v_dot2_f32_bf16 v29, v65, v13, v29
    v_dot2_f32_bf16 v30, v69, v13, v30
    v_dot2_f32_bf16 v31, v73, v13, v31
    v_dot2_f32_bf16 v28, v62, v14, v28
    v_dot2_f32_bf16 v29, v66, v14, v29
    v_dot2_f32_bf16 v30, v70, v14, v30
    v_dot2_f32_bf16 v31, v74, v14, v31
    v_dot2_f32_bf16 v28, v63, v15, v28
    v_dot2_f32_bf16 v29, v67, v15, v29
    v_dot2_f32_bf16 v30, v71, v15, v30
    v_dot2_f32_bf16 v31, v75, v15, v31
    s_mov_b32 s36, 16384
    buffer_load_dwordx4 v[60:63], v1, s[24:27], s36 offen offset:0 nt
    buffer_load_dwordx4 v[64:67], v1, s[24:27], s36 offen offset:1024 nt
    buffer_load_dwordx4 v[68:71], v1, s[24:27], s36 offen offset:2048 nt
    buffer_load_dwordx4 v[72:75], v1, s[24:27], s36 offen offset:3072 nt
    v_add_f32_dpp v28, v28, v28 row_ror:8 row_mask:0xf bank_mask:0xf
    v_add_f32_dpp v29, v29, v29 row_ror:8 row_mask:0xf bank_mask:0xf
    v_add_f32_dpp v30, v30, v30 row_ror:8 row_mask:0xf bank_mask:0xf
    v_add_f32_dpp v31, v31, v31 row_ror:8 row_mask:0xf bank_mask:0xf
    v_add_f32_dpp v28, v28, v28 row_ror:4 row_mask:0xf bank_mask:0xf
    v_add_f32_dpp v29, v29, v29 row_ror:4 row_mask:0xf bank_mask:0xf
    v_add_f32_dpp v30, v30, v30 row_ror:4 row_mask:0xf bank_mask:0xf
    v_add_f32_dpp v31, v31, v31 row_ror:4 row_mask:0xf bank_mask:0xf
    v_add_f32_dpp v28, v28, v28 row_ror:2 row_mask:0xf bank_mask:0xf
    v_add_f32_dpp v29, v29, v29 row_ror:2 row_mask:0xf bank_mask:0xf
    v_add_f32_dpp v30, v30, v30 row_ror:2 row_mask:0xf bank_mask:0xf
    v_add_f32_dpp v31, v31, v31 row_ror:2 row_mask:0xf bank_mask:0xf
    v_add_f32_dpp v28, v28, v28 row_ror:1 row_mask:0xf bank_mask:0xf
    v_add_f32_dpp v29, v29, v29 row_ror:1 row_mask:0xf bank_mask:0xf
    v_add_f32_dpp v30, v30, v30 row_ror:1 row_mask:0xf bank_mask:0xf
    v_add_f32_dpp v31, v31, v31 row_ror:1 row_mask:0xf bank_mask:0xf
    v_cvt_pk_bf16_f32 v3, v28, v29
    v_lshlrev_b32 v28, 16, v3
    v_and_b32 v29, 0xffff0000, v3
    v_mul_f32 v28, 0x3db504f3, v28
    v_mul_f32 v29, 0x3db504f3, v29
    v_cvt_pk_bf16_f32 v3, v28, v29
    v_lshlrev_b32 v28, 16, v3
    v_and_b32 v29, 0xffff0000, v3
    v_cvt_pk_bf16_f32 v3, v30, v31
    v_lshlrev_b32 v30, 16, v3
    v_and_b32 v31, 0xffff0000, v3
    v_mul_f32 v30, 0x3db504f3, v30
    v_mul_f32 v31, 0x3db504f3, v31
    v_cvt_pk_bf16_f32 v3, v30, v31
    v_lshlrev_b32 v30, 16, v3
    v_and_b32 v31, 0xffff0000, v3
    s_waitcnt vmcnt(12)
    v_dot2_f32_bf16 v32, v76, v12, 0
    v_dot2_f32_bf16 v33, v80, v12, 0
    v_dot2_f32_bf16 v34, v84, v12, 0
    v_dot2_f32_bf16 v35, v88, v12, 0
    v_dot2_f32_bf16 v32, v77, v13, v32
    v_dot2_f32_bf16 v33, v81, v13, v33
    v_dot2_f32_bf16 v34, v85, v13, v34
    v_dot2_f32_bf16 v35, v89, v13, v35
    v_dot2_f32_bf16 v32, v78, v14, v32
    v_dot2_f32_bf16 v33, v82, v14, v33
    v_dot2_f32_bf16 v34, v86, v14, v34
    v_dot2_f32_bf16 v35, v90, v14, v35
    v_dot2_f32_bf16 v32, v79, v15, v32
    v_dot2_f32_bf16 v33, v83, v15, v33
    v_dot2_f32_bf16 v34, v87, v15, v34
    v_dot2_f32_bf16 v35, v91, v15, v35
    s_mov_b32 s36, 20480
    buffer_load_dwordx4 v[76:79], v1, s[24:27], s36 offen offset:0 nt
    buffer_load_dwordx4 v[80:83], v1, s[24:27], s36 offen offset:1024 nt
    buffer_load_dwordx4 v[84:87], v1, s[24:27], s36 offen offset:2048 nt
    buffer_load_dwordx4 v[88:91], v1, s[24:27], s36 offen offset:3072 nt
    v_add_f32_dpp v32, v32, v32 row_ror:8 row_mask:0xf bank_mask:0xf
    v_add_f32_dpp v33, v33, v33 row_ror:8 row_mask:0xf bank_mask:0xf
    v_add_f32_dpp v34, v34, v34 row_ror:8 row_mask:0xf bank_mask:0xf
    v_add_f32_dpp v35, v35, v35 row_ror:8 row_mask:0xf bank_mask:0xf
    v_add_f32_dpp v32, v32, v32 row_ror:4 row_mask:0xf bank_mask:0xf
    v_add_f32_dpp v33, v33, v33 row_ror:4 row_mask:0xf bank_mask:0xf
    v_add_f32_dpp v34, v34, v34 row_ror:4 row_mask:0xf bank_mask:0xf
    v_add_f32_dpp v35, v35, v35 row_ror:4 row_mask:0xf bank_mask:0xf
    v_add_f32_dpp v32, v32, v32 row_ror:2 row_mask:0xf bank_mask:0xf
    v_add_f32_dpp v33, v33, v33 row_ror:2 row_mask:0xf bank_mask:0xf
    v_add_f32_dpp v34, v34, v34 row_ror:2 row_mask:0xf bank_mask:0xf
    v_add_f32_dpp v35, v35, v35 row_ror:2 row_mask:0xf bank_mask:0xf
    v_add_f32_dpp v32, v32, v32 row_ror:1 row_mask:0xf bank_mask:0xf
    v_add_f32_dpp v33, v33, v33 row_ror:1 row_mask:0xf bank_mask:0xf
    v_add_f32_dpp v34, v34, v34 row_ror:1 row_mask:0xf bank_mask:0xf
    v_add_f32_dpp v35, v35, v35 row_ror:1 row_mask:0xf bank_mask:0xf
    v_cvt_pk_bf16_f32 v3, v32, v33
    v_lshlrev_b32 v32, 16, v3
    v_and_b32 v33, 0xffff0000, v3
    v_mul_f32 v32, 0x3db504f3, v32
    v_mul_f32 v33, 0x3db504f3, v33
    v_cvt_pk_bf16_f32 v3, v32, v33
    v_lshlrev_b32 v32, 16, v3
    v_and_b32 v33, 0xffff0000, v3
    v_cvt_pk_bf16_f32 v3, v34, v35
    v_lshlrev_b32 v34, 16, v3
    v_and_b32 v35, 0xffff0000, v3
    v_mul_f32 v34, 0x3db504f3, v34
    v_mul_f32 v35, 0x3db504f3, v35
    v_cvt_pk_bf16_f32 v3, v34, v35
    v_lshlrev_b32 v34, 16, v3
    v_and_b32 v35, 0xffff0000, v3
    s_waitcnt vmcnt(12)
    v_dot2_f32_bf16 v36, v92, v12, 0
    v_dot2_f32_bf16 v37, v96, v12, 0
    v_dot2_f32_bf16 v38, v100, v12, 0
    v_dot2_f32_bf16 v39, v104, v12, 0
    v_dot2_f32_bf16 v36, v93, v13, v36
    v_dot2_f32_bf16 v37, v97, v13, v37
    v_dot2_f32_bf16 v38, v101, v13, v38
    v_dot2_f32_bf16 v39, v105, v13, v39
    v_dot2_f32_bf16 v36, v94, v14, v36
    v_dot2_f32_bf16 v37, v98, v14, v37
    v_dot2_f32_bf16 v38, v102, v14, v38
    v_dot2_f32_bf16 v39, v106, v14, v39
    v_dot2_f32_bf16 v36, v95, v15, v36
    v_dot2_f32_bf16 v37, v99, v15, v37
    v_dot2_f32_bf16 v38, v103, v15, v38
    v_dot2_f32_bf16 v39, v107, v15, v39
    s_mov_b32 s36, 24576
    buffer_load_dwordx4 v[92:95], v1, s[24:27], s36 offen offset:0 nt
    buffer_load_dwordx4 v[96:99], v1, s[24:27], s36 offen offset:1024 nt
    buffer_load_dwordx4 v[100:103], v1, s[24:27], s36 offen offset:2048 nt
    buffer_load_dwordx4 v[104:107], v1, s[24:27], s36 offen offset:3072 nt
    v_add_f32_dpp v36, v36, v36 row_ror:8 row_mask:0xf bank_mask:0xf
    v_add_f32_dpp v37, v37, v37 row_ror:8 row_mask:0xf bank_mask:0xf
    v_add_f32_dpp v38, v38, v38 row_ror:8 row_mask:0xf bank_mask:0xf
    v_add_f32_dpp v39, v39, v39 row_ror:8 row_mask:0xf bank_mask:0xf
    v_add_f32_dpp v36, v36, v36 row_ror:4 row_mask:0xf bank_mask:0xf
    v_add_f32_dpp v37, v37, v37 row_ror:4 row_mask:0xf bank_mask:0xf
    v_add_f32_dpp v38, v38, v38 row_ror:4 row_mask:0xf bank_mask:0xf
    v_add_f32_dpp v39, v39, v39 row_ror:4 row_mask:0xf bank_mask:0xf
    v_add_f32_dpp v36, v36, v36 row_ror:2 row_mask:0xf bank_mask:0xf
    v_add_f32_dpp v37, v37, v37 row_ror:2 row_mask:0xf bank_mask:0xf
    v_add_f32_dpp v38, v38, v38 row_ror:2 row_mask:0xf bank_mask:0xf
    v_add_f32_dpp v39, v39, v39 row_ror:2 row_mask:0xf bank_mask:0xf
    v_add_f32_dpp v36, v36, v36 row_ror:1 row_mask:0xf bank_mask:0xf
    v_add_f32_dpp v37, v37, v37 row_ror:1 row_mask:0xf bank_mask:0xf
    v_add_f32_dpp v38, v38, v38 row_ror:1 row_mask:0xf bank_mask:0xf
    v_add_f32_dpp v39, v39, v39 row_ror:1 row_mask:0xf bank_mask:0xf
    v_cvt_pk_bf16_f32 v3, v36, v37
    v_lshlrev_b32 v36, 16, v3
    v_and_b32 v37, 0xffff0000, v3
    v_mul_f32 v36, 0x3db504f3, v36
    v_mul_f32 v37, 0x3db504f3, v37
    v_cvt_pk_bf16_f32 v3, v36, v37
    v_lshlrev_b32 v36, 16, v3
    v_and_b32 v37, 0xffff0000, v3
    v_cvt_pk_bf16_f32 v3, v38, v39
    v_lshlrev_b32 v38, 16, v3
    v_and_b32 v39, 0xffff0000, v3
    v_mul_f32 v38, 0x3db504f3, v38
    v_mul_f32 v39, 0x3db504f3, v39
    v_cvt_pk_bf16_f32 v3, v38, v39
    v_lshlrev_b32 v38, 16, v3
    v_and_b32 v39, 0xffff0000, v3
    s_waitcnt vmcnt(12)
    v_dot2_f32_bf16 v40, v108, v12, 0
    v_dot2_f32_bf16 v41, v112, v12, 0
    v_dot2_f32_bf16 v42, v116, v12, 0
    v_dot2_f32_bf16 v43, v120, v12, 0
    v_dot2_f32_bf16 v40, v109, v13, v40
    v_dot2_f32_bf16 v41, v113, v13, v41
    v_dot2_f32_bf16 v42, v117, v13, v42
    v_dot2_f32_bf16 v43, v121, v13, v43
    v_dot2_f32_bf16 v40, v110, v14, v40
    v_dot2_f32_bf16 v41, v114, v14, v41
    v_dot2_f32_bf16 v42, v118, v14, v42
    v_dot2_f32_bf16 v43, v122, v14, v43
    v_dot2_f32_bf16 v40, v111, v15, v40
    v_dot2_f32_bf16 v41, v115, v15, v41
    v_dot2_f32_bf16 v42, v119, v15, v42
    v_dot2_f32_bf16 v43, v123, v15, v43
    s_mov_b32 s36, 28672
    buffer_load_dwordx4 v[108:111], v1, s[24:27], s36 offen offset:0 nt
    buffer_load_dwordx4 v[112:115], v1, s[24:27], s36 offen offset:1024 nt
    buffer_load_dwordx4 v[116:119], v1, s[24:27], s36 offen offset:2048 nt
    buffer_load_dwordx4 v[120:123], v1, s[24:27], s36 offen offset:3072 nt
    v_add_f32_dpp v40, v40, v40 row_ror:8 row_mask:0xf bank_mask:0xf
    v_add_f32_dpp v41, v41, v41 row_ror:8 row_mask:0xf bank_mask:0xf
    v_add_f32_dpp v42, v42, v42 row_ror:8 row_mask:0xf bank_mask:0xf
    v_add_f32_dpp v43, v43, v43 row_ror:8 row_mask:0xf bank_mask:0xf
    v_add_f32_dpp v40, v40, v40 row_ror:4 row_mask:0xf bank_mask:0xf
    v_add_f32_dpp v41, v41, v41 row_ror:4 row_mask:0xf bank_mask:0xf
    v_add_f32_dpp v42, v42, v42 row_ror:4 row_mask:0xf bank_mask:0xf
    v_add_f32_dpp v43, v43, v43 row_ror:4 row_mask:0xf bank_mask:0xf
    v_add_f32_dpp v40, v40, v40 row_ror:2 row_mask:0xf bank_mask:0xf
    v_add_f32_dpp v41, v41, v41 row_ror:2 row_mask:0xf bank_mask:0xf
    v_add_f32_dpp v42, v42, v42 row_ror:2 row_mask:0xf bank_mask:0xf
    v_add_f32_dpp v43, v43, v43 row_ror:2 row_mask:0xf bank_mask:0xf
    v_add_f32_dpp v40, v40, v40 row_ror:1 row_mask:0xf bank_mask:0xf
    v_add_f32_dpp v41, v41, v41 row_ror:1 row_mask:0xf bank_mask:0xf
    v_add_f32_dpp v42, v42, v42 row_ror:1 row_mask:0xf bank_mask:0xf
    v_add_f32_dpp v43, v43, v43 row_ror:1 row_mask:0xf bank_mask:0xf
    v_cvt_pk_bf16_f32 v3, v40, v41
    v_lshlrev_b32 v40, 16, v3
    v_and_b32 v41, 0xffff0000, v3
    v_mul_f32 v40, 0x3db504f3, v40
    v_mul_f32 v41, 0x3db504f3, v41
    v_cvt_pk_bf16_f32 v3, v40, v41
    v_lshlrev_b32 v40, 16, v3
    v_and_b32 v41, 0xffff0000, v3
    v_cvt_pk_bf16_f32 v3, v42, v43
    v_lshlrev_b32 v42, 16, v3
    v_and_b32 v43, 0xffff0000, v3
    v_mul_f32 v42, 0x3db504f3, v42
    v_mul_f32 v43, 0x3db504f3, v43
    v_cvt_pk_bf16_f32 v3, v42, v43
    v_lshlrev_b32 v42, 16, v3
    v_and_b32 v43, 0xffff0000, v3
    s_waitcnt vmcnt(12)
    v_dot2_f32_bf16 v44, v60, v12, 0
    v_dot2_f32_bf16 v45, v64, v12, 0
    v_dot2_f32_bf16 v46, v68, v12, 0
    v_dot2_f32_bf16 v47, v72, v12, 0
    v_dot2_f32_bf16 v44, v61, v13, v44
    v_dot2_f32_bf16 v45, v65, v13, v45
    v_dot2_f32_bf16 v46, v69, v13, v46
    v_dot2_f32_bf16 v47, v73, v13, v47
    v_dot2_f32_bf16 v44, v62, v14, v44
    v_dot2_f32_bf16 v45, v66, v14, v45
    v_dot2_f32_bf16 v46, v70, v14, v46
    v_dot2_f32_bf16 v47, v74, v14, v47
    v_dot2_f32_bf16 v44, v63, v15, v44
    v_dot2_f32_bf16 v45, v67, v15, v45
    v_dot2_f32_bf16 v46, v71, v15, v46
    v_dot2_f32_bf16 v47, v75, v15, v47
    s_mov_b32 s36, 0
    buffer_load_dwordx4 v[60:63], v1, s[28:31], s36 offen offset:0 nt
    buffer_load_dwordx4 v[64:67], v1, s[28:31], s36 offen offset:1024 nt
    buffer_load_dwordx4 v[68:71], v1, s[28:31], s36 offen offset:2048 nt
    buffer_load_dwordx4 v[72:75], v1, s[28:31], s36 offen offset:3072 nt
    v_add_f32_dpp v44, v44, v44 row_ror:8 row_mask:0xf bank_mask:0xf
    v_add_f32_dpp v45, v45, v45 row_ror:8 row_mask:0xf bank_mask:0xf
    v_add_f32_dpp v46, v46, v46 row_ror:8 row_mask:0xf bank_mask:0xf
    v_add_f32_dpp v47, v47, v47 row_ror:8 row_mask:0xf bank_mask:0xf
    v_add_f32_dpp v44, v44, v44 row_ror:4 row_mask:0xf bank_mask:0xf
    v_add_f32_dpp v45, v45, v45 row_ror:4 row_mask:0xf bank_mask:0xf
    v_add_f32_dpp v46, v46, v46 row_ror:4 row_mask:0xf bank_mask:0xf
    v_add_f32_dpp v47, v47, v47 row_ror:4 row_mask:0xf bank_mask:0xf
    v_add_f32_dpp v44, v44, v44 row_ror:2 row_mask:0xf bank_mask:0xf
    v_add_f32_dpp v45, v45, v45 row_ror:2 row_mask:0xf bank_mask:0xf
    v_add_f32_dpp v46, v46, v46 row_ror:2 row_mask:0xf bank_mask:0xf
    v_add_f32_dpp v47, v47, v47 row_ror:2 row_mask:0xf bank_mask:0xf
    v_add_f32_dpp v44, v44, v44 row_ror:1 row_mask:0xf bank_mask:0xf
    v_add_f32_dpp v45, v45, v45 row_ror:1 row_mask:0xf bank_mask:0xf
    v_add_f32_dpp v46, v46, v46 row_ror:1 row_mask:0xf bank_mask:0xf
    v_add_f32_dpp v47, v47, v47 row_ror:1 row_mask:0xf bank_mask:0xf
    v_cvt_pk_bf16_f32 v3, v44, v45
    v_lshlrev_b32 v44, 16, v3
    v_and_b32 v45, 0xffff0000, v3
    v_mul_f32 v44, 0x3db504f3, v44
    v_mul_f32 v45, 0x3db504f3, v45
    v_cvt_pk_bf16_f32 v3, v44, v45
    v_lshlrev_b32 v44, 16, v3
    v_and_b32 v45, 0xffff0000, v3
    v_cvt_pk_bf16_f32 v3, v46, v47
    v_lshlrev_b32 v46, 16, v3
    v_and_b32 v47, 0xffff0000, v3
    v_mul_f32 v46, 0x3db504f3, v46
    v_mul_f32 v47, 0x3db504f3, v47
    v_cvt_pk_bf16_f32 v3, v46, v47
    v_lshlrev_b32 v46, 16, v3
    v_and_b32 v47, 0xffff0000, v3
    s_waitcnt vmcnt(12)
    v_dot2_f32_bf16 v48, v76, v12, 0
    v_dot2_f32_bf16 v49, v80, v12, 0
    v_dot2_f32_bf16 v50, v84, v12, 0
    v_dot2_f32_bf16 v51, v88, v12, 0
    v_dot2_f32_bf16 v48, v77, v13, v48
    v_dot2_f32_bf16 v49, v81, v13, v49
    v_dot2_f32_bf16 v50, v85, v13, v50
    v_dot2_f32_bf16 v51, v89, v13, v51
    v_dot2_f32_bf16 v48, v78, v14, v48
    v_dot2_f32_bf16 v49, v82, v14, v49
    v_dot2_f32_bf16 v50, v86, v14, v50
    v_dot2_f32_bf16 v51, v90, v14, v51
    v_dot2_f32_bf16 v48, v79, v15, v48
    v_dot2_f32_bf16 v49, v83, v15, v49
    v_dot2_f32_bf16 v50, v87, v15, v50
    v_dot2_f32_bf16 v51, v91, v15, v51
    s_mov_b32 s36, 4096
    buffer_load_dwordx4 v[76:79], v1, s[28:31], s36 offen offset:0 nt
    buffer_load_dwordx4 v[80:83], v1, s[28:31], s36 offen offset:1024 nt
    buffer_load_dwordx4 v[84:87], v1, s[28:31], s36 offen offset:2048 nt
    buffer_load_dwordx4 v[88:91], v1, s[28:31], s36 offen offset:3072 nt
    v_add_f32_dpp v48, v48, v48 row_ror:8 row_mask:0xf bank_mask:0xf
    v_add_f32_dpp v49, v49, v49 row_ror:8 row_mask:0xf bank_mask:0xf
    v_add_f32_dpp v50, v50, v50 row_ror:8 row_mask:0xf bank_mask:0xf
    v_add_f32_dpp v51, v51, v51 row_ror:8 row_mask:0xf bank_mask:0xf
    v_add_f32_dpp v48, v48, v48 row_ror:4 row_mask:0xf bank_mask:0xf
    v_add_f32_dpp v49, v49, v49 row_ror:4 row_mask:0xf bank_mask:0xf
    v_add_f32_dpp v50, v50, v50 row_ror:4 row_mask:0xf bank_mask:0xf
    v_add_f32_dpp v51, v51, v51 row_ror:4 row_mask:0xf bank_mask:0xf
    v_add_f32_dpp v48, v48, v48 row_ror:2 row_mask:0xf bank_mask:0xf
    v_add_f32_dpp v49, v49, v49 row_ror:2 row_mask:0xf bank_mask:0xf
    v_add_f32_dpp v50, v50, v50 row_ror:2 row_mask:0xf bank_mask:0xf
    v_add_f32_dpp v51, v51, v51 row_ror:2 row_mask:0xf bank_mask:0xf
    v_add_f32_dpp v48, v48, v48 row_ror:1 row_mask:0xf bank_mask:0xf
    v_add_f32_dpp v49, v49, v49 row_ror:1 row_mask:0xf bank_mask:0xf
    v_add_f32_dpp v50, v50, v50 row_ror:1 row_mask:0xf bank_mask:0xf
    v_add_f32_dpp v51, v51, v51 row_ror:1 row_mask:0xf bank_mask:0xf
    v_cvt_pk_bf16_f32 v3, v48, v49
    v_lshlrev_b32 v48, 16, v3
    v_and_b32 v49, 0xffff0000, v3
    v_mul_f32 v48, 0x3db504f3, v48
    v_mul_f32 v49, 0x3db504f3, v49
    v_cvt_pk_bf16_f32 v3, v48, v49
    v_lshlrev_b32 v48, 16, v3
    v_and_b32 v49, 0xffff0000, v3
    v_cvt_pk_bf16_f32 v3, v50, v51
    v_lshlrev_b32 v50, 16, v3
    v_and_b32 v51, 0xffff0000, v3
    v_mul_f32 v50, 0x3db504f3, v50
    v_mul_f32 v51, 0x3db504f3, v51
    v_cvt_pk_bf16_f32 v3, v50, v51
    v_lshlrev_b32 v50, 16, v3
    v_and_b32 v51, 0xffff0000, v3
    s_waitcnt vmcnt(12)
    v_dot2_f32_bf16 v52, v92, v12, 0
    v_dot2_f32_bf16 v53, v96, v12, 0
    v_dot2_f32_bf16 v54, v100, v12, 0
    v_dot2_f32_bf16 v55, v104, v12, 0
    v_dot2_f32_bf16 v52, v93, v13, v52
    v_dot2_f32_bf16 v53, v97, v13, v53
    v_dot2_f32_bf16 v54, v101, v13, v54
    v_dot2_f32_bf16 v55, v105, v13, v55
    v_dot2_f32_bf16 v52, v94, v14, v52
    v_dot2_f32_bf16 v53, v98, v14, v53
    v_dot2_f32_bf16 v54, v102, v14, v54
    v_dot2_f32_bf16 v55, v106, v14, v55
    v_dot2_f32_bf16 v52, v95, v15, v52
    v_dot2_f32_bf16 v53, v99, v15, v53
    v_dot2_f32_bf16 v54, v103, v15, v54
    v_dot2_f32_bf16 v55, v107, v15, v55
    s_mov_b32 s36, 8192
    buffer_load_dwordx4 v[92:95], v1, s[28:31], s36 offen offset:0 nt
    buffer_load_dwordx4 v[96:99], v1, s[28:31], s36 offen offset:1024 nt
    buffer_load_dwordx4 v[100:103], v1, s[28:31], s36 offen offset:2048 nt
    buffer_load_dwordx4 v[104:107], v1, s[28:31], s36 offen offset:3072 nt
    v_add_f32_dpp v52, v52, v52 row_ror:8 row_mask:0xf bank_mask:0xf
    v_add_f32_dpp v53, v53, v53 row_ror:8 row_mask:0xf bank_mask:0xf
    v_add_f32_dpp v54, v54, v54 row_ror:8 row_mask:0xf bank_mask:0xf
    v_add_f32_dpp v55, v55, v55 row_ror:8 row_mask:0xf bank_mask:0xf
    v_add_f32_dpp v52, v52, v52 row_ror:4 row_mask:0xf bank_mask:0xf
    v_add_f32_dpp v53, v53, v53 row_ror:4 row_mask:0xf bank_mask:0xf
    v_add_f32_dpp v54, v54, v54 row_ror:4 row_mask:0xf bank_mask:0xf
    v_add_f32_dpp v55, v55, v55 row_ror:4 row_mask:0xf bank_mask:0xf
    v_add_f32_dpp v52, v52, v52 row_ror:2 row_mask:0xf bank_mask:0xf
    v_add_f32_dpp v53, v53, v53 row_ror:2 row_mask:0xf bank_mask:0xf
    v_add_f32_dpp v54, v54, v54 row_ror:2 row_mask:0xf bank_mask:0xf
    v_add_f32_dpp v55, v55, v55 row_ror:2 row_mask:0xf bank_mask:0xf
    v_add_f32_dpp v52, v52, v52 row_ror:1 row_mask:0xf bank_mask:0xf
    v_add_f32_dpp v53, v53, v53 row_ror:1 row_mask:0xf bank_mask:0xf
    v_add_f32_dpp v54, v54, v54 row_ror:1 row_mask:0xf bank_mask:0xf
    v_add_f32_dpp v55, v55, v55 row_ror:1 row_mask:0xf bank_mask:0xf
    v_cvt_pk_bf16_f32 v3, v52, v53
    v_lshlrev_b32 v52, 16, v3
    v_and_b32 v53, 0xffff0000, v3
    v_mul_f32 v52, 0x3db504f3, v52
    v_mul_f32 v53, 0x3db504f3, v53
    v_cvt_pk_bf16_f32 v3, v52, v53
    v_lshlrev_b32 v52, 16, v3
    v_and_b32 v53, 0xffff0000, v3
    v_cvt_pk_bf16_f32 v3, v54, v55
    v_lshlrev_b32 v54, 16, v3
    v_and_b32 v55, 0xffff0000, v3
    v_mul_f32 v54, 0x3db504f3, v54
    v_mul_f32 v55, 0x3db504f3, v55
    v_cvt_pk_bf16_f32 v3, v54, v55
    v_lshlrev_b32 v54, 16, v3
    v_and_b32 v55, 0xffff0000, v3
    s_waitcnt vmcnt(12)
    v_dot2_f32_bf16 v56, v108, v12, 0
    v_dot2_f32_bf16 v57, v112, v12, 0
    v_dot2_f32_bf16 v58, v116, v12, 0
    v_dot2_f32_bf16 v59, v120, v12, 0
    v_dot2_f32_bf16 v56, v109, v13, v56
    v_dot2_f32_bf16 v57, v113, v13, v57
    v_dot2_f32_bf16 v58, v117, v13, v58
    v_dot2_f32_bf16 v59, v121, v13, v59
    v_dot2_f32_bf16 v56, v110, v14, v56
    v_dot2_f32_bf16 v57, v114, v14, v57
    v_dot2_f32_bf16 v58, v118, v14, v58
    v_dot2_f32_bf16 v59, v122, v14, v59
    v_dot2_f32_bf16 v56, v111, v15, v56
    v_dot2_f32_bf16 v57, v115, v15, v57
    v_dot2_f32_bf16 v58, v119, v15, v58
    v_dot2_f32_bf16 v59, v123, v15, v59
    s_mov_b32 s36, 12288
    buffer_load_dwordx4 v[108:111], v1, s[28:31], s36 offen offset:0 nt
    buffer_load_dwordx4 v[112:115], v1, s[28:31], s36 offen offset:1024 nt
    buffer_load_dwordx4 v[116:119], v1, s[28:31], s36 offen offset:2048 nt
    buffer_load_dwordx4 v[120:123], v1, s[28:31], s36 offen offset:3072 nt
    v_add_f32_dpp v56, v56, v56 row_ror:8 row_mask:0xf bank_mask:0xf
    v_add_f32_dpp v57, v57, v57 row_ror:8 row_mask:0xf bank_mask:0xf
    v_add_f32_dpp v58, v58, v58 row_ror:8 row_mask:0xf bank_mask:0xf
    v_add_f32_dpp v59, v59, v59 row_ror:8 row_mask:0xf bank_mask:0xf
    v_add_f32_dpp v56, v56, v56 row_ror:4 row_mask:0xf bank_mask:0xf
    v_add_f32_dpp v57, v57, v57 row_ror:4 row_mask:0xf bank_mask:0xf
    v_add_f32_dpp v58, v58, v58 row_ror:4 row_mask:0xf bank_mask:0xf
    v_add_f32_dpp v59, v59, v59 row_ror:4 row_mask:0xf bank_mask:0xf
    v_add_f32_dpp v56, v56, v56 row_ror:2 row_mask:0xf bank_mask:0xf
    v_add_f32_dpp v57, v57, v57 row_ror:2 row_mask:0xf bank_mask:0xf
    v_add_f32_dpp v58, v58, v58 row_ror:2 row_mask:0xf bank_mask:0xf
    v_add_f32_dpp v59, v59, v59 row_ror:2 row_mask:0xf bank_mask:0xf
    v_add_f32_dpp v56, v56, v56 row_ror:1 row_mask:0xf bank_mask:0xf
    v_add_f32_dpp v57, v57, v57 row_ror:1 row_mask:0xf bank_mask:0xf
    v_add_f32_dpp v58, v58, v58 row_ror:1 row_mask:0xf bank_mask:0xf
    v_add_f32_dpp v59, v59, v59 row_ror:1 row_mask:0xf bank_mask:0xf
    v_cvt_pk_bf16_f32 v3, v56, v57
    v_lshlrev_b32 v56, 16, v3
    v_and_b32 v57, 0xffff0000, v3
    v_mul_f32 v56, 0x3db504f3, v56
    v_mul_f32 v57, 0x3db504f3, v57
    v_cvt_pk_bf16_f32 v3, v56, v57
    v_lshlrev_b32 v56, 16, v3
    v_and_b32 v57, 0xffff0000, v3
    v_cvt_pk_bf16_f32 v3, v58, v59
    v_lshlrev_b32 v58, 16, v3
    v_and_b32 v59, 0xffff0000, v3
    v_mul_f32 v58, 0x3db504f3, v58
    v_mul_f32 v59, 0x3db504f3, v59
    v_cvt_pk_bf16_f32 v3, v58, v59
    v_lshlrev_b32 v58, 16, v3
    v_and_b32 v59, 0xffff0000, v3
    v_max3_f32 v24, v28, v29, v30
    v_max3_f32 v24, v24, v31, v32
    v_max3_f32 v24, v24, v33, v34
    v_max3_f32 v24, v24, v35, v36
    v_max3_f32 v24, v24, v37, v38
    v_max3_f32 v24, v24, v39, v40
    v_max3_f32 v24, v24, v41, v42
    v_max3_f32 v24, v24, v43, v44
    v_max3_f32 v24, v24, v45, v46
    v_max3_f32 v24, v24, v47, v48
    v_max3_f32 v24, v24, v49, v50
    v_max3_f32 v24, v24, v51, v52
    v_max3_f32 v24, v24, v53, v54
    v_max3_f32 v24, v24, v55, v56
    v_max3_f32 v24, v24, v57, v58
    v_max_f32 v24, v24, v59
    v_mul_f32 v24, s39, v24
    v_fma_f32 v28, v28, s39, -v24
    v_fma_f32 v29, v29, s39, -v24
    v_fma_f32 v30, v30, s39, -v24
    v_fma_f32 v31, v31, s39, -v24
    v_fma_f32 v32, v32, s39, -v24
    v_fma_f32 v33, v33, s39, -v24
    v_fma_f32 v34, v34, s39, -v24
    v_fma_f32 v35, v35, s39, -v24
    v_fma_f32 v36, v36, s39, -v24
    v_fma_f32 v37, v37, s39, -v24
    v_fma_f32 v38, v38, s39, -v24
    v_fma_f32 v39, v39, s39, -v24
    v_fma_f32 v40, v40, s39, -v24
    v_fma_f32 v41, v41, s39, -v24
    v_fma_f32 v42, v42, s39, -v24
    v_fma_f32 v43, v43, s39, -v24
    v_fma_f32 v44, v44, s39, -v24
    v_fma_f32 v45, v45, s39, -v24
    v_fma_f32 v46, v46, s39, -v24
    v_fma_f32 v47, v47, s39, -v24
    v_fma_f32 v48, v48, s39, -v24
    v_fma_f32 v49, v49, s39, -v24
    v_fma_f32 v50, v50, s39, -v24
    v_fma_f32 v51, v51, s39, -v24
    v_fma_f32 v52, v52, s39, -v24
    v_fma_f32 v53, v53, s39, -v24
    v_fma_f32 v54, v54, s39, -v24
    v_fma_f32 v55, v55, s39, -v24
    v_fma_f32 v56, v56, s39, -v24
    v_fma_f32 v57, v57, s39, -v24
    v_fma_f32 v58, v58, s39, -v24
    v_fma_f32 v59, v59, s39, -v24
    v_exp_f32 v28, v28
    v_exp_f32 v29, v29
    v_exp_f32 v30, v30
    v_exp_f32 v31, v31
    v_exp_f32 v32, v32
    v_exp_f32 v33, v33
    v_exp_f32 v34, v34
    v_exp_f32 v35, v35
    v_exp_f32 v36, v36
    v_exp_f32 v37, v37
    v_exp_f32 v38, v38
    v_exp_f32 v39, v39
    v_exp_f32 v40, v40
    v_exp_f32 v41, v41
    v_exp_f32 v42, v42
    v_exp_f32 v43, v43
    v_exp_f32 v44, v44
    v_exp_f32 v45, v45
    v_exp_f32 v46, v46
    v_exp_f32 v47, v47
    v_exp_f32 v48, v48
    v_exp_f32 v49, v49
    v_exp_f32 v50, v50
    v_exp_f32 v51, v51
    v_exp_f32 v52, v52
    v_exp_f32 v53, v53
    v_exp_f32 v54, v54
    v_exp_f32 v55, v55
    v_exp_f32 v56, v56
    v_exp_f32 v57, v57
    v_exp_f32 v58, v58
    v_exp_f32 v59, v59
    v_add_f32 v25, v28, v29
    v_add_f32 v25, v25, v30
    v_add_f32 v25, v25, v31
    v_add_f32 v25, v25, v32
    v_add_f32 v25, v25, v33
    v_add_f32 v25, v25, v34
    v_add_f32 v25, v25, v35
    v_add_f32 v25, v25, v36
    v_add_f32 v25, v25, v37
    v_add_f32 v25, v25, v38
    v_add_f32 v25, v25, v39
    v_add_f32 v25, v25, v40
    v_add_f32 v25, v25, v41
    v_add_f32 v25, v25, v42
    v_add_f32 v25, v25, v43
    v_add_f32 v25, v25, v44
    v_add_f32 v25, v25, v45
    v_add_f32 v25, v25, v46
    v_add_f32 v25, v25, v47
    v_add_f32 v25, v25, v48
    v_add_f32 v25, v25, v49
    v_add_f32 v25, v25, v50
    v_add_f32 v25, v25, v51
    v_add_f32 v25, v25, v52
    v_add_f32 v25, v25, v53
    v_add_f32 v25, v25, v54
    v_add_f32 v25, v25, v55
    v_add_f32 v25, v25, v56
    v_add_f32 v25, v25, v57
    v_add_f32 v25, v25, v58
    v_add_f32 v25, v25, v59
    s_waitcnt vmcnt(12)
    v_lshlrev_b32 v26, 16, v60
    v_and_b32 v27, 0xffff0000, v60
    v_mul_f32 v16, v28, v26
    v_mul_f32 v17, v28, v27
    v_lshlrev_b32 v26, 16, v61
    v_and_b32 v27, 0xffff0000, v61
    v_mul_f32 v18, v28, v26
    v_mul_f32 v19, v28, v27
    v_lshlrev_b32 v26, 16, v62
    v_and_b32 v27, 0xffff0000, v62
    v_mul_f32 v20, v28, v26
    v_mul_f32 v21, v28, v27
    v_lshlrev_b32 v26, 16, v63
    v_and_b32 v27, 0xffff0000, v63
    v_mul_f32 v22, v28, v26
    v_mul_f32 v23, v28, v27
    v_lshlrev_b32 v26, 16, v64
    v_and_b32 v27, 0xffff0000, v64
    v_fmac_f32 v16, v29, v26
    v_fmac_f32 v17, v29, v27
    v_lshlrev_b32 v26, 16, v65
    v_and_b32 v27, 0xffff0000, v65
    v_fmac_f32 v18, v29, v26
    v_fmac_f32 v19, v29, v27
    v_lshlrev_b32 v26, 16, v66
    v_and_b32 v27, 0xffff0000, v66
    v_fmac_f32 v20, v29, v26
    v_fmac_f32 v21, v29, v27
    v_lshlrev_b32 v26, 16, v67
    v_and_b32 v27, 0xffff0000, v67
    v_fmac_f32 v22, v29, v26
    v_fmac_f32 v23, v29, v27
    v_lshlrev_b32 v26, 16, v68
    v_and_b32 v27, 0xffff0000, v68
    v_fmac_f32 v16, v30, v26
    v_fmac_f32 v17, v30, v27
    v_lshlrev_b32 v26, 16, v69
    v_and_b32 v27, 0xffff0000, v69
    v_fmac_f32 v18, v30, v26
    v_fmac_f32 v19, v30, v27
    v_lshlrev_b32 v26, 16, v70
    v_and_b32 v27, 0xffff0000, v70
    v_fmac_f32 v20, v30, v26
    v_fmac_f32 v21, v30, v27
    v_lshlrev_b32 v26, 16, v71
    v_and_b32 v27, 0xffff0000, v71
    v_fmac_f32 v22, v30, v26
    v_fmac_f32 v23, v30, v27
    v_lshlrev_b32 v26, 16, v72
    v_and_b32 v27, 0xffff0000, v72
    v_fmac_f32 v16, v31, v26
    v_fmac_f32 v17, v31, v27
    v_lshlrev_b32 v26, 16, v73
    v_and_b32 v27, 0xffff0000, v73
    v_fmac_f32 v18, v31, v26
    v_fmac_f32 v19, v31, v27
    v_lshlrev_b32 v26, 16, v74
    v_and_b32 v27, 0xffff0000, v74
    v_fmac_f32 v20, v31, v26
    v_fmac_f32 v21, v31, v27
    v_lshlrev_b32 v26, 16, v75
    v_and_b32 v27, 0xffff0000, v75
    v_fmac_f32 v22, v31, v26
    v_fmac_f32 v23, v31, v27
    s_mov_b32 s36, 16384
    buffer_load_dwordx4 v[60:63], v1, s[28:31], s36 offen offset:0 nt
    buffer_load_dwordx4 v[64:67], v1, s[28:31], s36 offen offset:1024 nt
    buffer_load_dwordx4 v[68:71], v1, s[28:31], s36 offen offset:2048 nt
    buffer_load_dwordx4 v[72:75], v1, s[28:31], s36 offen offset:3072 nt
    s_waitcnt vmcnt(12)
    v_lshlrev_b32 v26, 16, v76
    v_and_b32 v27, 0xffff0000, v76
    v_fmac_f32 v16, v32, v26
    v_fmac_f32 v17, v32, v27
    v_lshlrev_b32 v26, 16, v77
    v_and_b32 v27, 0xffff0000, v77
    v_fmac_f32 v18, v32, v26
    v_fmac_f32 v19, v32, v27
    v_lshlrev_b32 v26, 16, v78
    v_and_b32 v27, 0xffff0000, v78
    v_fmac_f32 v20, v32, v26
    v_fmac_f32 v21, v32, v27
    v_lshlrev_b32 v26, 16, v79
    v_and_b32 v27, 0xffff0000, v79
    v_fmac_f32 v22, v32, v26
    v_fmac_f32 v23, v32, v27
    v_lshlrev_b32 v26, 16, v80
    v_and_b32 v27, 0xffff0000, v80
    v_fmac_f32 v16, v33, v26
    v_fmac_f32 v17, v33, v27
    v_lshlrev_b32 v26, 16, v81
    v_and_b32 v27, 0xffff0000, v81
    v_fmac_f32 v18, v33, v26
    v_fmac_f32 v19, v33, v27
    v_lshlrev_b32 v26, 16, v82
    v_and_b32 v27, 0xffff0000, v82
    v_fmac_f32 v20, v33, v26
    v_fmac_f32 v21, v33, v27
    v_lshlrev_b32 v26, 16, v83
    v_and_b32 v27, 0xffff0000, v83
    v_fmac_f32 v22, v33, v26
    v_fmac_f32 v23, v33, v27
    v_lshlrev_b32 v26, 16, v84
    v_and_b32 v27, 0xffff0000, v84
    v_fmac_f32 v16, v34, v26
    v_fmac_f32 v17, v34, v27
    v_lshlrev_b32 v26, 16, v85
    v_and_b32 v27, 0xffff0000, v85
    v_fmac_f32 v18, v34, v26
    v_fmac_f32 v19, v34, v27
    v_lshlrev_b32 v26, 16, v86
    v_and_b32 v27, 0xffff0000, v86
    v_fmac_f32 v20, v34, v26
    v_fmac_f32 v21, v34, v27
    v_lshlrev_b32 v26, 16, v87
    v_and_b32 v27, 0xffff0000, v87
    v_fmac_f32 v22, v34, v26
    v_fmac_f32 v23, v34, v27
    v_lshlrev_b32 v26, 16, v88
    v_and_b32 v27, 0xffff0000, v88
    v_fmac_f32 v16, v35, v26
    v_fmac_f32 v17, v35, v27
    v_lshlrev_b32 v26, 16, v89
    v_and_b32 v27, 0xffff0000, v89
    v_fmac_f32 v18, v35, v26
    v_fmac_f32 v19, v35, v27
    v_lshlrev_b32 v26, 16, v90
    v_and_b32 v27, 0xffff0000, v90
    v_fmac_f32 v20, v35, v26
    v_fmac_f32 v21, v35, v27
    v_lshlrev_b32 v26, 16, v91
    v_and_b32 v27, 0xffff0000, v91
    v_fmac_f32 v22, v35, v26
    v_fmac_f32 v23, v35, v27
    s_mov_b32 s36, 20480
    buffer_load_dwordx4 v[76:79], v1, s[28:31], s36 offen offset:0 nt
    buffer_load_dwordx4 v[80:83], v1, s[28:31], s36 offen offset:1024 nt
    buffer_load_dwordx4 v[84:87], v1, s[28:31], s36 offen offset:2048 nt
    buffer_load_dwordx4 v[88:91], v1, s[28:31], s36 offen offset:3072 nt
    s_waitcnt vmcnt(12)
    v_lshlrev_b32 v26, 16, v92
    v_and_b32 v27, 0xffff0000, v92
    v_fmac_f32 v16, v36, v26
    v_fmac_f32 v17, v36, v27
    v_lshlrev_b32 v26, 16, v93
    v_and_b32 v27, 0xffff0000, v93
    v_fmac_f32 v18, v36, v26
    v_fmac_f32 v19, v36, v27
    v_lshlrev_b32 v26, 16, v94
    v_and_b32 v27, 0xffff0000, v94
    v_fmac_f32 v20, v36, v26
    v_fmac_f32 v21, v36, v27
    v_lshlrev_b32 v26, 16, v95
    v_and_b32 v27, 0xffff0000, v95
    v_fmac_f32 v22, v36, v26
    v_fmac_f32 v23, v36, v27
    v_lshlrev_b32 v26, 16, v96
    v_and_b32 v27, 0xffff0000, v96
    v_fmac_f32 v16, v37, v26
    v_fmac_f32 v17, v37, v27
    v_lshlrev_b32 v26, 16, v97
    v_and_b32 v27, 0xffff0000, v97
    v_fmac_f32 v18, v37, v26
    v_fmac_f32 v19, v37, v27
    v_lshlrev_b32 v26, 16, v98
    v_and_b32 v27, 0xffff0000, v98
    v_fmac_f32 v20, v37, v26
    v_fmac_f32 v21, v37, v27
    v_lshlrev_b32 v26, 16, v99
    v_and_b32 v27, 0xffff0000, v99
    v_fmac_f32 v22, v37, v26
    v_fmac_f32 v23, v37, v27
    v_lshlrev_b32 v26, 16, v100
    v_and_b32 v27, 0xffff0000, v100
    v_fmac_f32 v16, v38, v26
    v_fmac_f32 v17, v38, v27
    v_lshlrev_b32 v26, 16, v101
    v_and_b32 v27, 0xffff0000, v101
    v_fmac_f32 v18, v38, v26
    v_fmac_f32 v19, v38, v27
    v_lshlrev_b32 v26, 16, v102
    v_and_b32 v27, 0xffff0000, v102
    v_fmac_f32 v20, v38, v26
    v_fmac_f32 v21, v38, v27
    v_lshlrev_b32 v26, 16, v103
    v_and_b32 v27, 0xffff0000, v103
    v_fmac_f32 v22, v38, v26
    v_fmac_f32 v23, v38, v27
    v_lshlrev_b32 v26, 16, v104
    v_and_b32 v27, 0xffff0000, v104
    v_fmac_f32 v16, v39, v26
    v_fmac_f32 v17, v39, v27
    v_lshlrev_b32 v26, 16, v105
    v_and_b32 v27, 0xffff0000, v105
    v_fmac_f32 v18, v39, v26
    v_fmac_f32 v19, v39, v27
    v_lshlrev_b32 v26, 16, v106
    v_and_b32 v27, 0xffff0000, v106
    v_fmac_f32 v20, v39, v26
    v_fmac_f32 v21, v39, v27
    v_lshlrev_b32 v26, 16, v107
    v_and_b32 v27, 0xffff0000, v107
    v_fmac_f32 v22, v39, v26
    v_fmac_f32 v23, v39, v27
    s_mov_b32 s36, 24576
    buffer_load_dwordx4 v[92:95], v1, s[28:31], s36 offen offset:0 nt
    buffer_load_dwordx4 v[96:99], v1, s[28:31], s36 offen offset:1024 nt
    buffer_load_dwordx4 v[100:103], v1, s[28:31], s36 offen offset:2048 nt
    buffer_load_dwordx4 v[104:107], v1, s[28:31], s36 offen offset:3072 nt
    s_waitcnt vmcnt(12)
    v_lshlrev_b32 v26, 16, v108
    v_and_b32 v27, 0xffff0000, v108
    v_fmac_f32 v16, v40, v26
    v_fmac_f32 v17, v40, v27
    v_lshlrev_b32 v26, 16, v109
    v_and_b32 v27, 0xffff0000, v109
    v_fmac_f32 v18, v40, v26
    v_fmac_f32 v19, v40, v27
    v_lshlrev_b32 v26, 16, v110
    v_and_b32 v27, 0xffff0000, v110
    v_fmac_f32 v20, v40, v26
    v_fmac_f32 v21, v40, v27
    v_lshlrev_b32 v26, 16, v111
    v_and_b32 v27, 0xffff0000, v111
    v_fmac_f32 v22, v40, v26
    v_fmac_f32 v23, v40, v27
    v_lshlrev_b32 v26, 16, v112
    v_and_b32 v27, 0xffff0000, v112
    v_fmac_f32 v16, v41, v26
    v_fmac_f32 v17, v41, v27
    v_lshlrev_b32 v26, 16, v113
    v_and_b32 v27, 0xffff0000, v113
    v_fmac_f32 v18, v41, v26
    v_fmac_f32 v19, v41, v27
    v_lshlrev_b32 v26, 16, v114
    v_and_b32 v27, 0xffff0000, v114
    v_fmac_f32 v20, v41, v26
    v_fmac_f32 v21, v41, v27
    v_lshlrev_b32 v26, 16, v115
    v_and_b32 v27, 0xffff0000, v115
    v_fmac_f32 v22, v41, v26
    v_fmac_f32 v23, v41, v27
    v_lshlrev_b32 v26, 16, v116
    v_and_b32 v27, 0xffff0000, v116
    v_fmac_f32 v16, v42, v26
    v_fmac_f32 v17, v42, v27
    v_lshlrev_b32 v26, 16, v117
    v_and_b32 v27, 0xffff0000, v117
    v_fmac_f32 v18, v42, v26
    v_fmac_f32 v19, v42, v27
    v_lshlrev_b32 v26, 16, v118
    v_and_b32 v27, 0xffff0000, v118
    v_fmac_f32 v20, v42, v26
    v_fmac_f32 v21, v42, v27
    v_lshlrev_b32 v26, 16, v119
    v_and_b32 v27, 0xffff0000, v119
    v_fmac_f32 v22, v42, v26
    v_fmac_f32 v23, v42, v27
    v_lshlrev_b32 v26, 16, v120
    v_and_b32 v27, 0xffff0000, v120
    v_fmac_f32 v16, v43, v26
    v_fmac_f32 v17, v43, v27
    v_lshlrev_b32 v26, 16, v121
    v_and_b32 v27, 0xffff0000, v121
    v_fmac_f32 v18, v43, v26
    v_fmac_f32 v19, v43, v27
    v_lshlrev_b32 v26, 16, v122
    v_and_b32 v27, 0xffff0000, v122
    v_fmac_f32 v20, v43, v26
    v_fmac_f32 v21, v43, v27
    v_lshlrev_b32 v26, 16, v123
    v_and_b32 v27, 0xffff0000, v123
    v_fmac_f32 v22, v43, v26
    v_fmac_f32 v23, v43, v27
    s_mov_b32 s36, 28672
    buffer_load_dwordx4 v[108:111], v1, s[28:31], s36 offen offset:0 nt
    buffer_load_dwordx4 v[112:115], v1, s[28:31], s36 offen offset:1024 nt
    buffer_load_dwordx4 v[116:119], v1, s[28:31], s36 offen offset:2048 nt
    buffer_load_dwordx4 v[120:123], v1, s[28:31], s36 offen offset:3072 nt
    s_waitcnt vmcnt(12)
    v_lshlrev_b32 v26, 16, v60
    v_and_b32 v27, 0xffff0000, v60
    v_fmac_f32 v16, v44, v26
    v_fmac_f32 v17, v44, v27
    v_lshlrev_b32 v26, 16, v61
    v_and_b32 v27, 0xffff0000, v61
    v_fmac_f32 v18, v44, v26
    v_fmac_f32 v19, v44, v27
    v_lshlrev_b32 v26, 16, v62
    v_and_b32 v27, 0xffff0000, v62
    v_fmac_f32 v20, v44, v26
    v_fmac_f32 v21, v44, v27
    v_lshlrev_b32 v26, 16, v63
    v_and_b32 v27, 0xffff0000, v63
    v_fmac_f32 v22, v44, v26
    v_fmac_f32 v23, v44, v27
    v_lshlrev_b32 v26, 16, v64
    v_and_b32 v27, 0xffff0000, v64
    v_fmac_f32 v16, v45, v26
    v_fmac_f32 v17, v45, v27
    v_lshlrev_b32 v26, 16, v65
    v_and_b32 v27, 0xffff0000, v65
    v_fmac_f32 v18, v45, v26
    v_fmac_f32 v19, v45, v27
    v_lshlrev_b32 v26, 16, v66
    v_and_b32 v27, 0xffff0000, v66
    v_fmac_f32 v20, v45, v26
    v_fmac_f32 v21, v45, v27
    v_lshlrev_b32 v26, 16, v67
    v_and_b32 v27, 0xffff0000, v67
    v_fmac_f32 v22, v45, v26
    v_fmac_f32 v23, v45, v27
    v_lshlrev_b32 v26, 16, v68
    v_and_b32 v27, 0xffff0000, v68
    v_fmac_f32 v16, v46, v26
    v_fmac_f32 v17, v46, v27
    v_lshlrev_b32 v26, 16, v69
    v_and_b32 v27, 0xffff0000, v69
    v_fmac_f32 v18, v46, v26
    v_fmac_f32 v19, v46, v27
    v_lshlrev_b32 v26, 16, v70
    v_and_b32 v27, 0xffff0000, v70
    v_fmac_f32 v20, v46, v26
    v_fmac_f32 v21, v46, v27
    v_lshlrev_b32 v26, 16, v71
    v_and_b32 v27, 0xffff0000, v71
    v_fmac_f32 v22, v46, v26
    v_fmac_f32 v23, v46, v27
    v_lshlrev_b32 v26, 16, v72
    v_and_b32 v27, 0xffff0000, v72
    v_fmac_f32 v16, v47, v26
    v_fmac_f32 v17, v47, v27
    v_lshlrev_b32 v26, 16, v73
    v_and_b32 v27, 0xffff0000, v73
    v_fmac_f32 v18, v47, v26
    v_fmac_f32 v19, v47, v27
    v_lshlrev_b32 v26, 16, v74
    v_and_b32 v27, 0xffff0000, v74
    v_fmac_f32 v20, v47, v26
    v_fmac_f32 v21, v47, v27
    v_lshlrev_b32 v26, 16, v75
    v_and_b32 v27, 0xffff0000, v75
    v_fmac_f32 v22, v47, v26
    v_fmac_f32 v23, v47, v27
    s_waitcnt vmcnt(8)
    v_lshlrev_b32 v26, 16, v76
    v_and_b32 v27, 0xffff0000, v76
    v_fmac_f32 v16, v48, v26
    v_fmac_f32 v17, v48, v27
    v_lshlrev_b32 v26, 16, v77
    v_and_b32 v27, 0xffff0000, v77
    v_fmac_f32 v18, v48, v26
    v_fmac_f32 v19, v48, v27
    v_lshlrev_b32 v26, 16, v78
    v_and_b32 v27, 0xffff0000, v78
    v_fmac_f32 v20, v48, v26
    v_fmac_f32 v21, v48, v27
    v_lshlrev_b32 v26, 16, v79
    v_and_b32 v27, 0xffff0000, v79
    v_fmac_f32 v22, v48, v26
    v_fmac_f32 v23, v48, v27
    v_lshlrev_b32 v26, 16, v80
    v_and_b32 v27, 0xffff0000, v80
    v_fmac_f32 v16, v49, v26
    v_fmac_f32 v17, v49, v27
    v_lshlrev_b32 v26, 16, v81
    v_and_b32 v27, 0xffff0000, v81
    v_fmac_f32 v18, v49, v26
    v_fmac_f32 v19, v49, v27
    v_lshlrev_b32 v26, 16, v82
    v_and_b32 v27, 0xffff0000, v82
    v_fmac_f32 v20, v49, v26
    v_fmac_f32 v21, v49, v27
    v_lshlrev_b32 v26, 16, v83
    v_and_b32 v27, 0xffff0000, v83
    v_fmac_f32 v22, v49, v26
    v_fmac_f32 v23, v49, v27
    v_lshlrev_b32 v26, 16, v84
    v_and_b32 v27, 0xffff0000, v84
    v_fmac_f32 v16, v50, v26
    v_fmac_f32 v17, v50, v27
    v_lshlrev_b32 v26, 16, v85
    v_and_b32 v27, 0xffff0000, v85
    v_fmac_f32 v18, v50, v26
    v_fmac_f32 v19, v50, v27
    v_lshlrev_b32 v26, 16, v86
    v_and_b32 v27, 0xffff0000, v86
    v_fmac_f32 v20, v50, v26
    v_fmac_f32 v21, v50, v27
    v_lshlrev_b32 v26, 16, v87
    v_and_b32 v27, 0xffff0000, v87
    v_fmac_f32 v22, v50, v26
    v_fmac_f32 v23, v50, v27
    v_lshlrev_b32 v26, 16, v88
    v_and_b32 v27, 0xffff0000, v88
    v_fmac_f32 v16, v51, v26
    v_fmac_f32 v17, v51, v27
    v_lshlrev_b32 v26, 16, v89
    v_and_b32 v27, 0xffff0000, v89
    v_fmac_f32 v18, v51, v26
    v_fmac_f32 v19, v51, v27
    v_lshlrev_b32 v26, 16, v90
    v_and_b32 v27, 0xffff0000, v90
    v_fmac_f32 v20, v51, v26
    v_fmac_f32 v21, v51, v27
    v_lshlrev_b32 v26, 16, v91
    v_and_b32 v27, 0xffff0000, v91
    v_fmac_f32 v22, v51, v26
    v_fmac_f32 v23, v51, v27
    s_waitcnt vmcnt(4)
    v_lshlrev_b32 v26, 16, v92
    v_and_b32 v27, 0xffff0000, v92
    v_fmac_f32 v16, v52, v26
    v_fmac_f32 v17, v52, v27
    v_lshlrev_b32 v26, 16, v93
    v_and_b32 v27, 0xffff0000, v93
    v_fmac_f32 v18, v52, v26
    v_fmac_f32 v19, v52, v27
    v_lshlrev_b32 v26, 16, v94
    v_and_b32 v27, 0xffff0000, v94
    v_fmac_f32 v20, v52, v26
    v_fmac_f32 v21, v52, v27
    v_lshlrev_b32 v26, 16, v95
    v_and_b32 v27, 0xffff0000, v95
    v_fmac_f32 v22, v52, v26
    v_fmac_f32 v23, v52, v27
    v_lshlrev_b32 v26, 16, v96
    v_and_b32 v27, 0xffff0000, v96
    v_fmac_f32 v16, v53, v26
    v_fmac_f32 v17, v53, v27
    v_lshlrev_b32 v26, 16, v97
    v_and_b32 v27, 0xffff0000, v97
    v_fmac_f32 v18, v53, v26
    v_fmac_f32 v19, v53, v27
    v_lshlrev_b32 v26, 16, v98
    v_and_b32 v27, 0xffff0000, v98
    v_fmac_f32 v20, v53, v26
    v_fmac_f32 v21, v53, v27
    v_lshlrev_b32 v26, 16, v99
    v_and_b32 v27, 0xffff0000, v99
    v_fmac_f32 v22, v53, v26
    v_fmac_f32 v23, v53, v27
    v_lshlrev_b32 v26, 16, v100
    v_and_b32 v27, 0xffff0000, v100
    v_fmac_f32 v16, v54, v26
    v_fmac_f32 v17, v54, v27
    v_lshlrev_b32 v26, 16, v101
    v_and_b32 v27, 0xffff0000, v101
    v_fmac_f32 v18, v54, v26
    v_fmac_f32 v19, v54, v27
    v_lshlrev_b32 v26, 16, v102
    v_and_b32 v27, 0xffff0000, v102
    v_fmac_f32 v20, v54, v26
    v_fmac_f32 v21, v54, v27
    v_lshlrev_b32 v26, 16, v103
    v_and_b32 v27, 0xffff0000, v103
    v_fmac_f32 v22, v54, v26
    v_fmac_f32 v23, v54, v27
    v_lshlrev_b32 v26, 16, v104
    v_and_b32 v27, 0xffff0000, v104
    v_fmac_f32 v16, v55, v26
    v_fmac_f32 v17, v55, v27
    v_lshlrev_b32 v26, 16, v105
    v_and_b32 v27, 0xffff0000, v105
    v_fmac_f32 v18, v55, v26
    v_fmac_f32 v19, v55, v27
    v_lshlrev_b32 v26, 16, v106
    v_and_b32 v27, 0xffff0000, v106
    v_fmac_f32 v20, v55, v26
    v_fmac_f32 v21, v55, v27
    v_lshlrev_b32 v26, 16, v107
    v_and_b32 v27, 0xffff0000, v107
    v_fmac_f32 v22, v55, v26
    v_fmac_f32 v23, v55, v27
    s_waitcnt vmcnt(0)
    v_lshlrev_b32 v26, 16, v108
    v_and_b32 v27, 0xffff0000, v108
    v_fmac_f32 v16, v56, v26
    v_fmac_f32 v17, v56, v27
    v_lshlrev_b32 v26, 16, v109
    v_and_b32 v27, 0xffff0000, v109
    v_fmac_f32 v18, v56, v26
    v_fmac_f32 v19, v56, v27
    v_lshlrev_b32 v26, 16, v110
    v_and_b32 v27, 0xffff0000, v110
    v_fmac_f32 v20, v56, v26
    v_fmac_f32 v21, v56, v27
    v_lshlrev_b32 v26, 16, v111
    v_and_b32 v27, 0xffff0000, v111
    v_fmac_f32 v22, v56, v26
    v_fmac_f32 v23, v56, v27
    v_lshlrev_b32 v26, 16, v112
    v_and_b32 v27, 0xffff0000, v112
    v_fmac_f32 v16, v57, v26
    v_fmac_f32 v17, v57, v27
    v_lshlrev_b32 v26, 16, v113
    v_and_b32 v27, 0xffff0000, v113
    v_fmac_f32 v18, v57, v26
    v_fmac_f32 v19, v57, v27
    v_lshlrev_b32 v26, 16, v114
    v_and_b32 v27, 0xffff0000, v114
    v_fmac_f32 v20, v57, v26
    v_fmac_f32 v21, v57, v27
    v_lshlrev_b32 v26, 16, v115
    v_and_b32 v27, 0xffff0000, v115
    v_fmac_f32 v22, v57, v26
    v_fmac_f32 v23, v57, v27
    v_lshlrev_b32 v26, 16, v116
    v_and_b32 v27, 0xffff0000, v116
    v_fmac_f32 v16, v58, v26
    v_fmac_f32 v17, v58, v27
    v_lshlrev_b32 v26, 16, v117
    v_and_b32 v27, 0xffff0000, v117
    v_fmac_f32 v18, v58, v26
    v_fmac_f32 v19, v58, v27
    v_lshlrev_b32 v26, 16, v118
    v_and_b32 v27, 0xffff0000, v118
    v_fmac_f32 v20, v58, v26
    v_fmac_f32 v21, v58, v27
    v_lshlrev_b32 v26, 16, v119
    v_and_b32 v27, 0xffff0000, v119
    v_fmac_f32 v22, v58, v26
    v_fmac_f32 v23, v58, v27
    v_lshlrev_b32 v26, 16, v120
    v_and_b32 v27, 0xffff0000, v120
    v_fmac_f32 v16, v59, v26
    v_fmac_f32 v17, v59, v27
    v_lshlrev_b32 v26, 16, v121
    v_and_b32 v27, 0xffff0000, v121
    v_fmac_f32 v18, v59, v26
    v_fmac_f32 v19, v59, v27
    v_lshlrev_b32 v26, 16, v122
    v_and_b32 v27, 0xffff0000, v122
    v_fmac_f32 v20, v59, v26
    v_fmac_f32 v21, v59, v27
    v_lshlrev_b32 v26, 16, v123
    v_and_b32 v27, 0xffff0000, v123
    v_fmac_f32 v22, v59, v26
    v_fmac_f32 v23, v59, v27
    v_mov_b32 v3, v24
    v_mov_b32 v26, v24
    s_nop 1
    v_permlane32_swap_b32 v3, v26
    s_nop 1
    v_max_f32 v3, v3, v26
    v_mov_b32 v26, v3
    s_nop 1
    v_permlane16_swap_b32 v3, v26
    s_nop 1
    v_max_f32 v3, v3, v26
    v_sub_f32 v27, v24, v3
    v_exp_f32 v27, v27
    s_nop 0
    v_mul_f32 v16, v27, v16
    v_mul_f32 v17, v27, v17
    v_mul_f32 v18, v27, v18
    v_mul_f32 v19, v27, v19
    v_mul_f32 v20, v27, v20
    v_mul_f32 v21, v27, v21
    v_mul_f32 v22, v27, v22
    v_mul_f32 v23, v27, v23
    v_mul_f32 v25, v27, v25
    v_mov_b32 v28, v16
    v_mov_b32 v29, v17
    v_mov_b32 v30, v18
    v_mov_b32 v31, v19
    v_mov_b32 v32, v20
    v_mov_b32 v33, v21
    v_mov_b32 v34, v22
    v_mov_b32 v35, v23
    v_mov_b32 v36, v25
    s_nop 1
    v_permlane32_swap_b32 v16, v28
    v_permlane32_swap_b32 v17, v29
    v_permlane32_swap_b32 v18, v30
    v_permlane32_swap_b32 v19, v31
    v_permlane32_swap_b32 v20, v32
    v_permlane32_swap_b32 v21, v33
    v_permlane32_swap_b32 v22, v34
    v_permlane32_swap_b32 v23, v35
    v_permlane32_swap_b32 v25, v36
    s_nop 1
    v_add_f32 v16, v16, v28
    v_add_f32 v17, v17, v29
    v_add_f32 v18, v18, v30
    v_add_f32 v19, v19, v31
    v_add_f32 v20, v20, v32
    v_add_f32 v21, v21, v33
    v_add_f32 v22, v22, v34
    v_add_f32 v23, v23, v35
    v_add_f32 v25, v25, v36
    v_mov_b32 v28, v16
    v_mov_b32 v29, v17
    v_mov_b32 v30, v18
    v_mov_b32 v31, v19
    v_mov_b32 v32, v20
    v_mov_b32 v33, v21
    v_mov_b32 v34, v22
    v_mov_b32 v35, v23
    v_mov_b32 v36, v25
    s_nop 1
    v_permlane16_swap_b32 v16, v28
    v_permlane16_swap_b32 v17, v29
    v_permlane16_swap_b32 v18, v30
    v_permlane16_swap_b32 v19, v31
    v_permlane16_swap_b32 v20, v32
    v_permlane16_swap_b32 v21, v33
    v_permlane16_swap_b32 v22, v34
    v_permlane16_swap_b32 v23, v35
    v_permlane16_swap_b32 v25, v36
    s_nop 1
    v_add_f32 v16, v16, v28
    v_add_f32 v17, v17, v29
    v_add_f32 v18, v18, v30
    v_add_f32 v19, v19, v31
    v_add_f32 v20, v20, v32
    v_add_f32 v21, v21, v33
    v_add_f32 v22, v22, v34
    v_add_f32 v23, v23, v35
    v_add_f32 v25, v25, v36
    v_mov_b32 v26, v25
    v_mov_b32 v27, v26
    v_mov_b32 v26, v3
    v_lshlrev_b32 v3, 5, v2
    s_lshl_b32 s38, s14, 9
    v_add_u32 v3, s38, v3
    s_mov_b64 exec, 0xffff
    ds_write_b128 v3, v[16:19] offset:4096
    ds_write_b128 v3, v[20:23] offset:4112
    s_lshl_b32 s38, s14, 3
    v_mov_b32 v3, s38
    ds_write_b64 v3, v[26:27] offset:2304
    s_mov_b64 exec, -1
    s_waitcnt lgkmcnt(0)
    s_barrier
    s_cmp_ge_u32 s14, 2
    s_cbranch_scc1 A_done
    v_mov_b32 v3, 0
    ds_read_b64 v[28:29], v3 offset:2304
    ds_read_b64 v[30:31], v3 offset:2312
    ds_read_b64 v[32:33], v3 offset:2320
    ds_read_b64 v[34:35], v3 offset:2328
    ds_read_b64 v[36:37], v3 offset:2336
    ds_read_b64 v[38:39], v3 offset:2344
    ds_read_b64 v[40:41], v3 offset:2352
    ds_read_b64 v[42:43], v3 offset:2360
    ds_read_b64 v[44:45], v3 offset:2368
    ds_read_b64 v[46:47], v3 offset:2376
    ds_read_b64 v[48:49], v3 offset:2384
    ds_read_b64 v[50:51], v3 offset:2392
    ds_read_b64 v[52:53], v3 offset:2400
    ds_read_b64 v[54:55], v3 offset:2408
    ds_read_b64 v[56:57], v3 offset:2416
    ds_read_b64 v[58:59], v3 offset:2424
    v_lshlrev_b32 v3, 2, v0
    ds_read_b32 v60, v3 offset:4096
    ds_read_b32 v61, v3 offset:4608
    ds_read_b32 v62, v3 offset:5120
    ds_read_b32 v63, v3 offset:5632
    ds_read_b32 v64, v3 offset:6144
    ds_read_b32 v65, v3 offset:6656
    ds_read_b32 v66, v3 offset:7168
    ds_read_b32 v67, v3 offset:7680
    ds_read_b32 v68, v3 offset:8192
    ds_read_b32 v69, v3 offset:8704
    ds_read_b32 v70, v3 offset:9216
    ds_read_b32 v71, v3 offset:9728
    ds_read_b32 v72, v3 offset:10240
    ds_read_b32 v73, v3 offset:10752
    ds_read_b32 v74, v3 offset:11264
    ds_read_b32 v75, v3 offset:11776
    s_waitcnt lgkmcnt(0)
    v_max3_f32 v24, v28, v30, v32
    v_max3_f32 v24, v24, v34, v36
    v_max3_f32 v24, v24, v38, v40
    v_max3_f32 v24, v24, v42, v44
    v_max3_f32 v24, v24, v46, v48
    v_max3_f32 v24, v24, v50, v52
    v_max3_f32 v24, v24, v54, v56
    v_max_f32 v24, v24, v58
    v_sub_f32 v28, v28, v24
    v_sub_f32 v30, v30, v24
    v_sub_f32 v32, v32, v24
    v_sub_f32 v34, v34, v24
    v_sub_f32 v36, v36, v24
    v_sub_f32 v38, v38, v24
    v_sub_f32 v40, v40, v24
    v_sub_f32 v42, v42, v24
    v_sub_f32 v44, v44, v24
    v_sub_f32 v46, v46, v24
    v_sub_f32 v48, v48, v24
    v_sub_f32 v50, v50, v24
    v_sub_f32 v52, v52, v24
    v_sub_f32 v54, v54, v24
    v_sub_f32 v56, v56, v24
    v_sub_f32 v58, v58, v24
    v_exp_f32 v28, v28
    v_exp_f32 v30, v30
    v_exp_f32 v32, v32
    v_exp_f32 v34, v34
    v_exp_f32 v36, v36
    v_exp_f32 v38, v38
    v_exp_f32 v40, v40
    v_exp_f32 v42, v42
    v_exp_f32 v44, v44
    v_exp_f32 v46, v46
    v_exp_f32 v48, v48
    v_exp_f32 v50, v50
    v_exp_f32 v52, v52
    v_exp_f32 v54, v54
    v_exp_f32 v56, v56
    v_exp_f32 v58, v58
    s_nop 0
    v_mul_f32 v25, v28, v29
    v_mul_f32 v16, v28, v60
    v_fmac_f32 v25, v30, v31
    v_fmac_f32 v16, v30, v61
    v_fmac_f32 v25, v32, v33
    v_fmac_f32 v16, v32, v62
    v_fmac_f32 v25, v34, v35
    v_fmac_f32 v16, v34, v63
    v_fmac_f32 v25, v36, v37
    v_fmac_f32 v16, v36, v64
    v_fmac_f32 v25, v38, v39
    v_fmac_f32 v16, v38, v65
    v_fmac_f32 v25, v40, v41
    v_fmac_f32 v16, v40, v66
    v_fmac_f32 v25, v42, v43
    v_fmac_f32 v16, v42, v67
    v_fmac_f32 v25, v44, v45
    v_fmac_f32 v16, v44, v68
    v_fmac_f32 v25, v46, v47
    v_fmac_f32 v16, v46, v69
    v_fmac_f32 v25, v48, v49
    v_fmac_f32 v16, v48, v70
    v_fmac_f32 v25, v50, v51
    v_fmac_f32 v16, v50, v71
    v_fmac_f32 v25, v52, v53
    v_fmac_f32 v16, v52, v72
    v_fmac_f32 v25, v54, v55
    v_fmac_f32 v16, v54, v73
    v_fmac_f32 v25, v56, v57
    v_fmac_f32 v16, v56, v74
    v_fmac_f32 v25, v58, v59
    v_fmac_f32 v16, v58, v75
    buffer_store_dword v16, v3, s[32:35], 0 offen
    v_mov_b32 v26, v24
    v_mov_b32 v27, v25
    v_mov_b32 v3, 512
    s_mov_b64 exec, 1
    buffer_store_dwordx2 v[26:27], v3, s[32:35], 0 offen
    s_mov_b64 exec, -1
A_done:
    s_endpgm

.globl wo_kernel
.p2align 8
.type wo_kernel,@function
wo_kernel:
    s_cmp_ge_u32 s2, 256
    s_cbranch_scc1 W_done
    s_load_dwordx2 s[4:5], s[0:1], 32
    s_load_dwordx2 s[6:7], s[0:1], 88
    v_and_b32 v1, 63, v0
    v_lshrrev_b32 v2, 6, v0
    s_nop 0
    v_readfirstlane_b32 s14, v2
    s_lshr_b32 s15, s2, 3
    s_and_b32 s3, s2, 7
    s_waitcnt lgkmcnt(0)
    s_lshl_b32 s28, s15, 17
    s_lshl_b32 s29, s3, 7
    s_add_u32 s28, s28, s29
    s_add_u32 s16, s4, s28
    s_addc_u32 s17, s5, 0
    s_sub_u32 s18, 4194304, s28
    s_mov_b32 s19, 0x00020000
    s_lshl_b32 s28, s15, 13
    s_add_u32 s28, s28, 0
    s_add_u32 s20, s6, s28
    s_addc_u32 s21, s7, 0
    s_mov_b32 s22, 8192
    s_mov_b32 s23, 0x00020000
    s_lshl_b32 s28, s15, 11
    s_lshl_b32 s29, s3, 8
    s_add_u32 s28, s28, s29
    s_add_u32 s28, s28, 1048576
    s_add_u32 s24, s6, s28
    s_addc_u32 s25, s7, 0
    s_mov_b32 s26, 256
    s_mov_b32 s27, 0x00020000
    v_and_b32 v3, 127, v0
    v_lshlrev_b32 v3, 2, v3
    v_mov_b32 v4, 512
    s_mov_b32 s29, 4096
    buffer_load_dword v24, v3, s[20:23], 0 offen offset:0
    buffer_load_dword v25, v3, s[20:23], 0 offen offset:1024
    buffer_load_dword v26, v3, s[20:23], 0 offen offset:2048
    buffer_load_dword v27, v3, s[20:23], 0 offen offset:3072
    buffer_load_dword v28, v3, s[20:23], s29 offen offset:0
    buffer_load_dword v29, v3, s[20:23], s29 offen offset:1024
    buffer_load_dword v30, v3, s[20:23], s29 offen offset:2048
    buffer_load_dword v31, v3, s[20:23], s29 offen offset:3072
    buffer_load_dwordx2 v[32:33], v4, s[20:23], 0 offen offset:0
    buffer_load_dwordx2 v[34:35], v4, s[20:23], 0 offen offset:1024
    buffer_load_dwordx2 v[36:37], v4, s[20:23], 0 offen offset:2048
    buffer_load_dwordx2 v[38:39], v4, s[20:23], 0 offen offset:3072
    buffer_load_dwordx2 v[40:41], v4, s[20:23], s29 offen offset:0
    buffer_load_dwordx2 v[42:43], v4, s[20:23], s29 offen offset:1024
    buffer_load_dwordx2 v[44:45], v4, s[20:23], s29 offen offset:2048
    buffer_load_dwordx2 v[46:47], v4, s[20:23], s29 offen offset:3072
    v_lshrrev_b32 v2, 3, v1
    v_lshlrev_b32 v2, 10, v2
    v_and_b32 v3, 7, v1
    v_lshl_add_u32 v2, v3, 4, v2
    s_lshl_b32 s29, s14, 15
    buffer_load_dwordx4 v[8:11], v2, s[16:19], s29 offen nt
    s_add_u32 s29, s29, 0x2000
    buffer_load_dwordx4 v[12:15], v2, s[16:19], s29 offen nt
    s_add_u32 s29, s29, 0x2000
    buffer_load_dwordx4 v[16:19], v2, s[16:19], s29 offen nt
    s_add_u32 s29, s29, 0x2000
    buffer_load_dwordx4 v[20:23], v2, s[16:19], s29 offen nt
    s_waitcnt vmcnt(4)
    v_max3_f32 v2, v32, v34, v36
    v_max3_f32 v2, v2, v38, v40
    v_max3_f32 v2, v2, v42, v44
    v_max_f32 v2, v2, v46
    v_sub_f32 v32, v32, v2
    v_sub_f32 v34, v34, v2
    v_sub_f32 v36, v36, v2
    v_sub_f32 v38, v38, v2
    v_sub_f32 v40, v40, v2
    v_sub_f32 v42, v42, v2
    v_sub_f32 v44, v44, v2
    v_sub_f32 v46, v46, v2
    v_exp_f32 v32, v32
    v_exp_f32 v34, v34
    v_exp_f32 v36, v36
    v_exp_f32 v38, v38
    v_exp_f32 v40, v40
    v_exp_f32 v42, v42
    v_exp_f32 v44, v44
    v_exp_f32 v46, v46
    s_nop 0
    v_mul_f32 v2, v32, v33
    v_mul_f32 v3, v32, v24
    v_fmac_f32 v2, v34, v35
    v_fmac_f32 v3, v34, v25
    v_fmac_f32 v2, v36, v37
    v_fmac_f32 v3, v36, v26
    v_fmac_f32 v2, v38, v39
    v_fmac_f32 v3, v38, v27
    v_fmac_f32 v2, v40, v41
    v_fmac_f32 v3, v40, v28
    v_fmac_f32 v2, v42, v43
    v_fmac_f32 v3, v42, v29
    v_fmac_f32 v2, v44, v45
    v_fmac_f32 v3, v44, v30
    v_fmac_f32 v2, v46, v47
    v_fmac_f32 v3, v46, v31
    v_rcp_f32 v4, v2
    s_nop 0
    v_mul_f32 v24, v3, v4
    v_fma_f32 v25, -v24, v2, v3
    v_fma_f32 v24, v25, v4, v24
    v_cvt_pk_bf16_f32 v2, v24, v24
    v_lshlrev_b32 v24, 16, v2
    v_and_b32 v3, 127, v0
    v_lshlrev_b32 v2, 2, v3
    ds_write_b32 v2, v24 offset:0
    s_waitcnt lgkmcnt(0)
    s_barrier
    v_lshrrev_b32 v2, 3, v1
    v_lshlrev_b32 v2, 2, v2
    s_lshl_b32 s28, s14, 7
    v_add_u32 v2, s28, v2
    ds_read_b32 v56, v2 offset:0
    ds_read_b32 v57, v2 offset:32
    ds_read_b32 v58, v2 offset:64
    ds_read_b32 v59, v2 offset:96
    s_waitcnt vmcnt(0) lgkmcnt(0)
    v_lshlrev_b32 v3, 16, v8
    v_and_b32 v4, 0xffff0000, v8
    v_mul_f32 v48, v56, v3
    v_mul_f32 v49, v56, v4
    v_lshlrev_b32 v3, 16, v9
    v_and_b32 v4, 0xffff0000, v9
    v_mul_f32 v50, v56, v3
    v_mul_f32 v51, v56, v4
    v_lshlrev_b32 v3, 16, v10
    v_and_b32 v4, 0xffff0000, v10
    v_mul_f32 v52, v56, v3
    v_mul_f32 v53, v56, v4
    v_lshlrev_b32 v3, 16, v11
    v_and_b32 v4, 0xffff0000, v11
    v_mul_f32 v54, v56, v3
    v_mul_f32 v55, v56, v4
    v_lshlrev_b32 v3, 16, v12
    v_and_b32 v4, 0xffff0000, v12
    v_fmac_f32 v48, v57, v3
    v_fmac_f32 v49, v57, v4
    v_lshlrev_b32 v3, 16, v13
    v_and_b32 v4, 0xffff0000, v13
    v_fmac_f32 v50, v57, v3
    v_fmac_f32 v51, v57, v4
    v_lshlrev_b32 v3, 16, v14
    v_and_b32 v4, 0xffff0000, v14
    v_fmac_f32 v52, v57, v3
    v_fmac_f32 v53, v57, v4
    v_lshlrev_b32 v3, 16, v15
    v_and_b32 v4, 0xffff0000, v15
    v_fmac_f32 v54, v57, v3
    v_fmac_f32 v55, v57, v4
    v_lshlrev_b32 v3, 16, v16
    v_and_b32 v4, 0xffff0000, v16
    v_fmac_f32 v48, v58, v3
    v_fmac_f32 v49, v58, v4
    v_lshlrev_b32 v3, 16, v17
    v_and_b32 v4, 0xffff0000, v17
    v_fmac_f32 v50, v58, v3
    v_fmac_f32 v51, v58, v4
    v_lshlrev_b32 v3, 16, v18
    v_and_b32 v4, 0xffff0000, v18
    v_fmac_f32 v52, v58, v3
    v_fmac_f32 v53, v58, v4
    v_lshlrev_b32 v3, 16, v19
    v_and_b32 v4, 0xffff0000, v19
    v_fmac_f32 v54, v58, v3
    v_fmac_f32 v55, v58, v4
    v_lshlrev_b32 v3, 16, v20
    v_and_b32 v4, 0xffff0000, v20
    v_fmac_f32 v48, v59, v3
    v_fmac_f32 v49, v59, v4
    v_lshlrev_b32 v3, 16, v21
    v_and_b32 v4, 0xffff0000, v21
    v_fmac_f32 v50, v59, v3
    v_fmac_f32 v51, v59, v4
    v_lshlrev_b32 v3, 16, v22
    v_and_b32 v4, 0xffff0000, v22
    v_fmac_f32 v52, v59, v3
    v_fmac_f32 v53, v59, v4
    v_lshlrev_b32 v3, 16, v23
    v_and_b32 v4, 0xffff0000, v23
    v_fmac_f32 v54, v59, v3
    v_fmac_f32 v55, v59, v4
    s_nop 1
    v_add_f32_dpp v48, v48, v48 row_ror:8 row_mask:0xf bank_mask:0xf
    v_add_f32_dpp v49, v49, v49 row_ror:8 row_mask:0xf bank_mask:0xf
    v_add_f32_dpp v50, v50, v50 row_ror:8 row_mask:0xf bank_mask:0xf
    v_add_f32_dpp v51, v51, v51 row_ror:8 row_mask:0xf bank_mask:0xf
    v_add_f32_dpp v52, v52, v52 row_ror:8 row_mask:0xf bank_mask:0xf
    v_add_f32_dpp v53, v53, v53 row_ror:8 row_mask:0xf bank_mask:0xf
    v_add_f32_dpp v54, v54, v54 row_ror:8 row_mask:0xf bank_mask:0xf
    v_add_f32_dpp v55, v55, v55 row_ror:8 row_mask:0xf bank_mask:0xf
    v_lshrrev_b32 v2, 4, v1
    v_lshlrev_b32 v2, 8, v2
    v_and_b32 v3, 7, v1
    v_lshl_add_u32 v2, v3, 5, v2
    s_lshl_b32 s28, s14, 10
    v_add_u32 v2, s28, v2
    s_mov_b32 s30, 0x00ff00ff
    s_mov_b32 s31, 0x00ff00ff
    s_mov_b64 exec, s[30:31]
    ds_write_b128 v2, v[48:51] offset:512
    ds_write_b128 v2, v[52:55] offset:528
    s_mov_b64 exec, -1
    s_waitcnt lgkmcnt(0)
    s_barrier
    s_cmp_ge_u32 s14, 1
    s_cbranch_scc1 W_done
    v_lshlrev_b32 v2, 2, v0
    ds_read_b32 v32, v2 offset:512
    ds_read_b32 v33, v2 offset:768
    ds_read_b32 v34, v2 offset:1024
    ds_read_b32 v35, v2 offset:1280
    ds_read_b32 v36, v2 offset:1536
    ds_read_b32 v37, v2 offset:1792
    ds_read_b32 v38, v2 offset:2048
    ds_read_b32 v39, v2 offset:2304
    ds_read_b32 v40, v2 offset:2560
    ds_read_b32 v41, v2 offset:2816
    ds_read_b32 v42, v2 offset:3072
    ds_read_b32 v43, v2 offset:3328
    ds_read_b32 v44, v2 offset:3584
    ds_read_b32 v45, v2 offset:3840
    ds_read_b32 v46, v2 offset:4096
    ds_read_b32 v47, v2 offset:4352
    s_waitcnt lgkmcnt(0)
    v_add_f32 v3, v32, v33
    v_add_f32 v3, v3, v34
    v_add_f32 v3, v3, v35
    v_add_f32 v3, v3, v36
    v_add_f32 v3, v3, v37
    v_add_f32 v3, v3, v38
    v_add_f32 v3, v3, v39
    v_add_f32 v3, v3, v40
    v_add_f32 v3, v3, v41
    v_add_f32 v3, v3, v42
    v_add_f32 v3, v3, v43
    v_add_f32 v3, v3, v44
    v_add_f32 v3, v3, v45
    v_add_f32 v3, v3, v46
    v_add_f32 v3, v3, v47
    buffer_store_dword v3, v2, s[24:27], 0 offen
W_done:
    s_endpgm

.globl geglu_kernel
.p2align 8
.type geglu_kernel,@function
geglu_kernel:
    s_cmp_ge_u32 s2, 224
    s_cbranch_scc1 G_done
    s_load_dwordx2 s[4:5], s[0:1], 0
    s_load_dwordx4 s[8:11], s[0:1], 48
    s_load_dwordx2 s[6:7], s[0:1], 88
    v_and_b32 v1, 63, v0
    v_lshrrev_b32 v2, 6, v0
    s_nop 0
    v_readfirstlane_b32 s14, v2
    s_lshr_b32 s3, s2, 3
    s_and_b32 s15, s2, 7
    s_waitcnt lgkmcnt(0)
    s_mul_i32 s40, s15, 229376
    s_lshl_b32 s41, s3, 7
    s_add_u32 s40, s40, s41
    s_add_u32 s16, s8, s40
    s_addc_u32 s17, s9, 0
    s_sub_u32 s18, 1835008, s40
    s_mov_b32 s19, 0x00020000
    s_add_u32 s20, s10, s40
    s_addc_u32 s21, s11, 0
    s_sub_u32 s22, 1835008, s40
    s_mov_b32 s23, 0x00020000
    s_mov_b32 s40, 1048576
    s_add_u32 s24, s6, s40
    s_addc_u32 s25, s7, 0
    s_mov_b32 s26, 65536
    s_mov_b32 s27, 0x00020000
    s_mov_b32 s28, s4
    s_mov_b32 s29, s5
    s_mov_b32 s30, 1024
    s_mov_b32 s31, 0x00020000
    s_mov_b32 s40, 2097152
    s_add_u32 s32, s6, s40
    s_addc_u32 s33, s7, 0
    s_mov_b32 s34, 2048
    s_mov_b32 s35, 0x00020000
    s_mul_i32 s40, s15, 14336
    s_lshl_b32 s41, s3, 8
    s_add_u32 s40, s40, s41
    s_add_u32 s40, s40, 3145728
    s_add_u32 s36, s6, s40
    s_addc_u32 s37, s7, 0
    s_mov_b32 s38, 7424
    s_mov_b32 s39, 0x00020000
    v_lshlrev_b32 v2, 3, v0
    buffer_load_dwordx2 v[8:9], v2, s[24:27], 0 offen offset:0
    buffer_load_dwordx2 v[10:11], v2, s[24:27], 0 offen offset:2048
    v_add_u32 v2, 4096, v2
    buffer_load_dwordx2 v[12:13], v2, s[24:27], 0 offen offset:0
    buffer_load_dwordx2 v[14:15], v2, s[24:27], 0 offen offset:2048
    v_add_u32 v2, 4096, v2
    buffer_load_dwordx2 v[16:17], v2, s[24:27], 0 offen offset:0
    buffer_load_dwordx2 v[18:19], v2, s[24:27], 0 offen offset:2048
    v_add_u32 v2, 4096, v2
    buffer_load_dwordx2 v[20:21], v2, s[24:27], 0 offen offset:0
    buffer_load_dwordx2 v[22:23], v2, s[24:27], 0 offen offset:2048
    v_add_u32 v2, 4096, v2
    buffer_load_dwordx2 v[24:25], v2, s[24:27], 0 offen offset:0
    buffer_load_dwordx2 v[26:27], v2, s[24:27], 0 offen offset:2048
    v_add_u32 v2, 4096, v2
    buffer_load_dwordx2 v[28:29], v2, s[24:27], 0 offen offset:0
    buffer_load_dwordx2 v[30:31], v2, s[24:27], 0 offen offset:2048
    v_add_u32 v2, 4096, v2
    buffer_load_dwordx2 v[32:33], v2, s[24:27], 0 offen offset:0
    buffer_load_dwordx2 v[34:35], v2, s[24:27], 0 offen offset:2048
    v_add_u32 v2, 4096, v2
    buffer_load_dwordx2 v[36:37], v2, s[24:27], 0 offen offset:0
    buffer_load_dwordx2 v[38:39], v2, s[24:27], 0 offen offset:2048
    v_add_u32 v2, 4096, v2
    buffer_load_dwordx2 v[40:41], v2, s[24:27], 0 offen offset:0
    buffer_load_dwordx2 v[42:43], v2, s[24:27], 0 offen offset:2048
    v_add_u32 v2, 4096, v2
    buffer_load_dwordx2 v[44:45], v2, s[24:27], 0 offen offset:0
    buffer_load_dwordx2 v[46:47], v2, s[24:27], 0 offen offset:2048
    v_add_u32 v2, 4096, v2
    buffer_load_dwordx2 v[48:49], v2, s[24:27], 0 offen offset:0
    buffer_load_dwordx2 v[50:51], v2, s[24:27], 0 offen offset:2048
    v_add_u32 v2, 4096, v2
    buffer_load_dwordx2 v[52:53], v2, s[24:27], 0 offen offset:0
    buffer_load_dwordx2 v[54:55], v2, s[24:27], 0 offen offset:2048
    v_add_u32 v2, 4096, v2
    buffer_load_dwordx2 v[56:57], v2, s[24:27], 0 offen offset:0
    buffer_load_dwordx2 v[58:59], v2, s[24:27], 0 offen offset:2048
    v_add_u32 v2, 4096, v2
    buffer_load_dwordx2 v[60:61], v2, s[24:27], 0 offen offset:0
    buffer_load_dwordx2 v[62:63], v2, s[24:27], 0 offen offset:2048
    v_add_u32 v2, 4096, v2
    buffer_load_dwordx2 v[64:65], v2, s[24:27], 0 offen offset:0
    buffer_load_dwordx2 v[66:67], v2, s[24:27], 0 offen offset:2048
    v_add_u32 v2, 4096, v2
    buffer_load_dwordx2 v[68:69], v2, s[24:27], 0 offen offset:0
    buffer_load_dwordx2 v[70:71], v2, s[24:27], 0 offen offset:2048
    v_lshlrev_b32 v3, 2, v0
    buffer_load_dword v5, v3, s[28:31], 0 offen
    v_lshrrev_b32 v2, 3, v1
    v_mul_u32_u24 v2, 3584, v2
    v_and_b32 v3, 7, v1
    v_lshl_add_u32 v2, v3, 4, v2
    s_mul_i32 s41, s14, 57344
    buffer_load_dwordx4 v[72:75], v2, s[16:19], s41 offen nt
    buffer_load_dwordx4 v[80:83], v2, s[20:23], s41 offen nt
    s_add_u32 s41, s41, 28672
    buffer_load_dwordx4 v[76:79], v2, s[16:19], s41 offen nt
    buffer_load_dwordx4 v[84:87], v2, s[20:23], s41 offen nt
    s_waitcnt vmcnt(4)
    v_add_f32 v6, v8, v10
    v_add_f32 v7, v9, v11
    v_add_f32 v6, v6, v12
    v_add_f32 v7, v7, v13
    v_add_f32 v6, v6, v14
    v_add_f32 v7, v7, v15
    v_add_f32 v6, v6, v16
    v_add_f32 v7, v7, v17
    v_add_f32 v6, v6, v18
    v_add_f32 v7, v7, v19
    v_add_f32 v6, v6, v20
    v_add_f32 v7, v7, v21
    v_add_f32 v6, v6, v22
    v_add_f32 v7, v7, v23
    v_add_f32 v6, v6, v24
    v_add_f32 v7, v7, v25
    v_add_f32 v6, v6, v26
    v_add_f32 v7, v7, v27
    v_add_f32 v6, v6, v28
    v_add_f32 v7, v7, v29
    v_add_f32 v6, v6, v30
    v_add_f32 v7, v7, v31
    v_add_f32 v6, v6, v32
    v_add_f32 v7, v7, v33
    v_add_f32 v6, v6, v34
    v_add_f32 v7, v7, v35
    v_add_f32 v6, v6, v36
    v_add_f32 v7, v7, v37
    v_add_f32 v6, v6, v38
    v_add_f32 v7, v7, v39
    v_add_f32 v6, v6, v40
    v_add_f32 v7, v7, v41
    v_add_f32 v6, v6, v42
    v_add_f32 v7, v7, v43
    v_add_f32 v6, v6, v44
    v_add_f32 v7, v7, v45
    v_add_f32 v6, v6, v46
    v_add_f32 v7, v7, v47
    v_add_f32 v6, v6, v48
    v_add_f32 v7, v7, v49
    v_add_f32 v6, v6, v50
    v_add_f32 v7, v7, v51
    v_add_f32 v6, v6, v52
    v_add_f32 v7, v7, v53
    v_add_f32 v6, v6, v54
    v_add_f32 v7, v7, v55
    v_add_f32 v6, v6, v56
    v_add_f32 v7, v7, v57
    v_add_f32 v6, v6, v58
    v_add_f32 v7, v7, v59
    v_add_f32 v6, v6, v60
    v_add_f32 v7, v7, v61
    v_add_f32 v6, v6, v62
    v_add_f32 v7, v7, v63
    v_add_f32 v6, v6, v64
    v_add_f32 v7, v7, v65
    v_add_f32 v6, v6, v66
    v_add_f32 v7, v7, v67
    v_add_f32 v6, v6, v68
    v_add_f32 v7, v7, v69
    v_add_f32 v6, v6, v70
    v_add_f32 v7, v7, v71
    v_cvt_pk_bf16_f32 v2, v6, v6
    v_lshlrev_b32 v6, 16, v2
    v_cvt_pk_bf16_f32 v2, v7, v7
    v_lshlrev_b32 v7, 16, v2
    v_lshlrev_b32 v3, 16, v5
    v_and_b32 v4, 0xffff0000, v5
    v_add_f32 v6, v3, v6
    v_add_f32 v7, v4, v7
    v_cvt_pk_bf16_f32 v2, v6, v6
    v_lshlrev_b32 v6, 16, v2
    v_cvt_pk_bf16_f32 v2, v7, v7
    v_lshlrev_b32 v7, 16, v2
    s_cmp_lg_u32 s2, 0
    s_cbranch_scc1 G_noh
    v_lshlrev_b32 v3, 3, v0
    buffer_store_dwordx2 v[6:7], v3, s[32:35], 0 offen
G_noh:
    v_add_f32 v2, v6, v7
    s_nop 1
    v_add_f32_dpp v2, v2, v2 row_ror:8 row_mask:0xf bank_mask:0xf
    s_nop 1
    v_add_f32_dpp v2, v2, v2 row_ror:4 row_mask:0xf bank_mask:0xf
    s_nop 1
    v_add_f32_dpp v2, v2, v2 row_ror:2 row_mask:0xf bank_mask:0xf
    s_nop 1
    v_add_f32_dpp v2, v2, v2 row_ror:1 row_mask:0xf bank_mask:0xf
    s_nop 0
    v_readlane_b32 s44, v2, 0
    v_readlane_b32 s45, v2, 16
    v_readlane_b32 s46, v2, 32
    v_readlane_b32 s47, v2, 48
    s_nop 1
    v_mov_b32 v2, s44
    v_add_f32 v2, s45, v2
    v_add_f32 v2, s46, v2
    v_add_f32 v2, s47, v2
    s_lshl_b32 s40, s14, 2
    v_mov_b32 v3, s40
    ds_write_b32 v3, v2 offset:0
    s_waitcnt lgkmcnt(0)
    s_barrier
    v_mov_b32 v3, 0
    ds_read_b128 v[8:11], v3 offset:0
    s_waitcnt lgkmcnt(0)
    v_add_f32 v2, v8, v9
    v_add_f32 v3, v10, v11
    v_add_f32 v2, v2, v3
    v_mul_f32 v8, 0x3b000000, v2
    v_sub_f32 v3, v6, v8
    v_sub_f32 v4, v7, v8
    v_mul_f32 v2, v3, v3
    v_fmac_f32 v2, v4, v4
    s_nop 1
    v_add_f32_dpp v2, v2, v2 row_ror:8 row_mask:0xf bank_mask:0xf
    s_nop 1
    v_add_f32_dpp v2, v2, v2 row_ror:4 row_mask:0xf bank_mask:0xf
    s_nop 1
    v_add_f32_dpp v2, v2, v2 row_ror:2 row_mask:0xf bank_mask:0xf
    s_nop 1
    v_add_f32_dpp v2, v2, v2 row_ror:1 row_mask:0xf bank_mask:0xf
    s_nop 0
    v_readlane_b32 s44, v2, 0
    v_readlane_b32 s45, v2, 16
    v_readlane_b32 s46, v2, 32
    v_readlane_b32 s47, v2, 48
    s_nop 1
    v_mov_b32 v2, s44
    v_add_f32 v2, s45, v2
    v_add_f32 v2, s46, v2
    v_add_f32 v2, s47, v2
    v_mov_b32 v3, s40
    ds_write_b32 v3, v2 offset:16
    s_waitcnt lgkmcnt(0)
    s_barrier
    v_mov_b32 v3, 0
    ds_read_b128 v[12:15], v3 offset:16
    s_waitcnt lgkmcnt(0)
    v_add_f32 v2, v12, v13
    v_add_f32 v3, v14, v15
    v_add_f32 v2, v2, v3
    v_mul_f32 v9, 0x3b000000, v2
    v_cvt_pk_bf16_f32 v2, v8, v8
    v_lshlrev_b32 v8, 16, v2
    v_cvt_pk_bf16_f32 v2, v9, v9
    v_lshlrev_b32 v9, 16, v2
    v_add_f32 v9, 0x3727c5ac, v9
    v_cvt_pk_bf16_f32 v2, v9, v9
    v_lshlrev_b32 v9, 16, v2
    v_sqrt_f32 v3, v9
    s_nop 0
    v_fma_f32 v4, -v3, v3, v9
    v_rcp_f32 v5, v3
    s_nop 0
    v_mul_f32 v5, 0.5, v5
    v_fma_f32 v3, v4, v5, v3
    v_cvt_pk_bf16_f32 v4, v3, v3
    v_lshlrev_b32 v3, 16, v4
    v_rcp_f32 v5, v3
    v_sub_f32 v10, v6, v8
    v_cvt_pk_bf16_f32 v4, v10, v10
    v_lshlrev_b32 v10, 16, v4
    v_mul_f32 v12, v10, v5
    v_fma_f32 v13, -v12, v3, v10
    v_fma_f32 v10, v13, v5, v12
    v_cvt_pk_bf16_f32 v4, v10, v10
    v_lshlrev_b32 v10, 16, v4
    v_sub_f32 v11, v7, v8
    v_cvt_pk_bf16_f32 v4, v11, v11
    v_lshlrev_b32 v11, 16, v4
    v_mul_f32 v12, v11, v5
    v_fma_f32 v13, -v12, v3, v11
    v_fma_f32 v11, v13, v5, v12
    v_cvt_pk_bf16_f32 v4, v11, v11
    v_lshlrev_b32 v11, 16, v4
    v_lshlrev_b32 v2, 3, v0
    ds_write_b64 v2, v[10:11] offset:64
    s_waitcnt lgkmcnt(0)
    s_barrier
    v_lshrrev_b32 v2, 3, v1
    v_lshlrev_b32 v2, 2, v2
    s_lshl_b32 s40, s14, 6
    s_lshl_b32 s41, s15, 8
    s_add_u32 s40, s40, s41
    v_add_u32 v2, s40, v2
    ds_read_b32 v88, v2 offset:64
    ds_read_b32 v89, v2 offset:96
    s_waitcnt vmcnt(0) lgkmcnt(0)
    v_lshlrev_b32 v3, 16, v72
    v_and_b32 v4, 0xffff0000, v72
    v_mul_f32 v92, v88, v3
    v_mul_f32 v93, v88, v4
    v_lshlrev_b32 v3, 16, v73
    v_and_b32 v4, 0xffff0000, v73
    v_mul_f32 v94, v88, v3
    v_mul_f32 v95, v88, v4
    v_lshlrev_b32 v3, 16, v74
    v_and_b32 v4, 0xffff0000, v74
    v_mul_f32 v96, v88, v3
    v_mul_f32 v97, v88, v4
    v_lshlrev_b32 v3, 16, v75
    v_and_b32 v4, 0xffff0000, v75
    v_mul_f32 v98, v88, v3
    v_mul_f32 v99, v88, v4
    v_lshlrev_b32 v3, 16, v76
    v_and_b32 v4, 0xffff0000, v76
    v_fmac_f32 v92, v89, v3
    v_fmac_f32 v93, v89, v4
    v_lshlrev_b32 v3, 16, v77
    v_and_b32 v4, 0xffff0000, v77
    v_fmac_f32 v94, v89, v3
    v_fmac_f32 v95, v89, v4
    v_lshlrev_b32 v3, 16, v78
    v_and_b32 v4, 0xffff0000, v78
    v_fmac_f32 v96, v89, v3
    v_fmac_f32 v97, v89, v4
    v_lshlrev_b32 v3, 16, v79
    v_and_b32 v4, 0xffff0000, v79
    v_fmac_f32 v98, v89, v3
    v_fmac_f32 v99, v89, v4
    v_lshlrev_b32 v3, 16, v80
    v_and_b32 v4, 0xffff0000, v80
    v_mul_f32 v100, v88, v3
    v_mul_f32 v101, v88, v4
    v_lshlrev_b32 v3, 16, v81
    v_and_b32 v4, 0xffff0000, v81
    v_mul_f32 v102, v88, v3
    v_mul_f32 v103, v88, v4
    v_lshlrev_b32 v3, 16, v82
    v_and_b32 v4, 0xffff0000, v82
    v_mul_f32 v104, v88, v3
    v_mul_f32 v105, v88, v4
    v_lshlrev_b32 v3, 16, v83
    v_and_b32 v4, 0xffff0000, v83
    v_mul_f32 v106, v88, v3
    v_mul_f32 v107, v88, v4
    v_lshlrev_b32 v3, 16, v84
    v_and_b32 v4, 0xffff0000, v84
    v_fmac_f32 v100, v89, v3
    v_fmac_f32 v101, v89, v4
    v_lshlrev_b32 v3, 16, v85
    v_and_b32 v4, 0xffff0000, v85
    v_fmac_f32 v102, v89, v3
    v_fmac_f32 v103, v89, v4
    v_lshlrev_b32 v3, 16, v86
    v_and_b32 v4, 0xffff0000, v86
    v_fmac_f32 v104, v89, v3
    v_fmac_f32 v105, v89, v4
    v_lshlrev_b32 v3, 16, v87
    v_and_b32 v4, 0xffff0000, v87
    v_fmac_f32 v106, v89, v3
    v_fmac_f32 v107, v89, v4
    s_nop 1
    v_add_f32_dpp v92, v92, v92 row_ror:8 row_mask:0xf bank_mask:0xf
    v_add_f32_dpp v93, v93, v93 row_ror:8 row_mask:0xf bank_mask:0xf
    v_add_f32_dpp v94, v94, v94 row_ror:8 row_mask:0xf bank_mask:0xf
    v_add_f32_dpp v95, v95, v95 row_ror:8 row_mask:0xf bank_mask:0xf
    v_add_f32_dpp v96, v96, v96 row_ror:8 row_mask:0xf bank_mask:0xf
    v_add_f32_dpp v97, v97, v97 row_ror:8 row_mask:0xf bank_mask:0xf
    v_add_f32_dpp v98, v98, v98 row_ror:8 row_mask:0xf bank_mask:0xf
    v_add_f32_dpp v99, v99, v99 row_ror:8 row_mask:0xf bank_mask:0xf
    v_add_f32_dpp v100, v100, v100 row_ror:8 row_mask:0xf bank_mask:0xf
    v_add_f32_dpp v101, v101, v101 row_ror:8 row_mask:0xf bank_mask:0xf
    v_add_f32_dpp v102, v102, v102 row_ror:8 row_mask:0xf bank_mask:0xf
    v_add_f32_dpp v103, v103, v103 row_ror:8 row_mask:0xf bank_mask:0xf
    v_add_f32_dpp v104, v104, v104 row_ror:8 row_mask:0xf bank_mask:0xf
    v_add_f32_dpp v105, v105, v105 row_ror:8 row_mask:0xf bank_mask:0xf
    v_add_f32_dpp v106, v106, v106 row_ror:8 row_mask:0xf bank_mask:0xf
    v_add_f32_dpp v107, v107, v107 row_ror:8 row_mask:0xf bank_mask:0xf
    v_lshrrev_b32 v2, 4, v1
    v_lshlrev_b32 v2, 9, v2
    v_and_b32 v3, 7, v1
    v_lshl_add_u32 v2, v3, 5, v2
    s_lshl_b32 s40, s14, 11
    v_add_u32 v2, s40, v2
    s_mov_b32 s42, 0x00ff00ff
    s_mov_b32 s43, 0x00ff00ff
    s_mov_b64 exec, s[42:43]
    ds_write_b128 v2, v[92:95] offset:2112
    ds_write_b128 v2, v[96:99] offset:2128
    ds_write_b128 v2, v[100:103] offset:2368
    ds_write_b128 v2, v[104:107] offset:2384
    s_mov_b64 exec, -1
    s_waitcnt lgkmcnt(0)
    s_barrier
    s_cmp_ge_u32 s14, 2
    s_cbranch_scc1 G_done
    v_lshlrev_b32 v2, 2, v0
    ds_read_b32 v8, v2 offset:2112
    ds_read_b32 v9, v2 offset:2624
    ds_read_b32 v10, v2 offset:3136
    ds_read_b32 v11, v2 offset:3648
    ds_read_b32 v12, v2 offset:4160
    ds_read_b32 v13, v2 offset:4672
    ds_read_b32 v14, v2 offset:5184
    ds_read_b32 v15, v2 offset:5696
    ds_read_b32 v16, v2 offset:6208
    ds_read_b32 v17, v2 offset:6720
    ds_read_b32 v18, v2 offset:7232
    ds_read_b32 v19, v2 offset:7744
    ds_read_b32 v20, v2 offset:8256
    ds_read_b32 v21, v2 offset:8768
    ds_read_b32 v22, v2 offset:9280
    ds_read_b32 v23, v2 offset:9792
    s_waitcnt lgkmcnt(0)
    v_add_f32 v3, v8, v9
    v_add_f32 v3, v3, v10
    v_add_f32 v3, v3, v11
    v_add_f32 v3, v3, v12
    v_add_f32 v3, v3, v13
    v_add_f32 v3, v3, v14
    v_add_f32 v3, v3, v15
    v_add_f32 v3, v3, v16
    v_add_f32 v3, v3, v17
    v_add_f32 v3, v3, v18
    v_add_f32 v3, v3, v19
    v_add_f32 v3, v3, v20
    v_add_f32 v3, v3, v21
    v_add_f32 v3, v3, v22
    v_add_f32 v3, v3, v23
    v_lshrrev_b32 v4, 6, v0
    v_mul_u32_u24 v4, 7168, v4
    v_and_b32 v2, 63, v0
    v_lshl_add_u32 v2, v2, 2, v4
    buffer_store_dword v3, v2, s[36:39], 0 offen
G_done:
    s_endpgm

.globl down_kernel
.p2align 8
.type down_kernel,@function
down_kernel:
    s_cmp_ge_u32 s2, 256
    s_cbranch_scc1 D_done
    s_load_dwordx2 s[4:5], s[0:1], 64
    s_load_dwordx2 s[6:7], s[0:1], 88
    s_lshr_b32 s15, s2, 3
    s_and_b32 s3, s2, 7
    s_waitcnt lgkmcnt(0)
    s_mul_i32 s28, s15, 57344
    s_lshl_b32 s29, s3, 7
    s_add_u32 s28, s28, s29
    s_add_u32 s16, s4, s28
    s_addc_u32 s17, s5, 0
    s_sub_u32 s18, 1835008, s28
    s_mov_b32 s19, 0x00020000
    s_mul_i32 s28, s15, 224
    s_add_u32 s28, s28, 3145728
    s_add_u32 s20, s6, s28
    s_addc_u32 s21, s7, 0
    s_mov_b32 s22, 107744
    s_mov_b32 s23, 0x00020000
    s_lshl_b32 s28, s15, 11
    s_lshl_b32 s29, s3, 8
    s_add_u32 s28, s28, s29
    s_add_u32 s28, s28, 4194304
    s_add_u32 s24, s6, s28
    s_addc_u32 s25, s7, 0
    s_mov_b32 s26, 256
    s_mov_b32 s27, 0x00020000
    v_min_u32 v2, 55, v0
    v_lshlrev_b32 v2, 2, v2
    s_mov_b32 s29, 0
    buffer_load_dword v8, v2, s[20:23], s29 offen
    s_mov_b32 s29, 7168
    buffer_load_dword v9, v2, s[20:23], s29 offen
    s_mov_b32 s29, 14336
    buffer_load_dword v10, v2, s[20:23], s29 offen
    s_mov_b32 s29, 21504
    buffer_load_dword v11, v2, s[20:23], s29 offen
    s_mov_b32 s29, 28672
    buffer_load_dword v12, v2, s[20:23], s29 offen
    s_mov_b32 s29, 35840
    buffer_load_dword v13, v2, s[20:23], s29 offen
    s_mov_b32 s29, 43008
    buffer_load_dword v14, v2, s[20:23], s29 offen
    s_mov_b32 s29, 50176
    buffer_load_dword v15, v2, s[20:23], s29 offen
    s_mov_b32 s29, 57344
    buffer_load_dword v16, v2, s[20:23], s29 offen
    s_mov_b32 s29, 64512
    buffer_load_dword v17, v2, s[20:23], s29 offen
    s_mov_b32 s29, 71680
    buffer_load_dword v18, v2, s[20:23], s29 offen
    s_mov_b32 s29, 78848
    buffer_load_dword v19, v2, s[20:23], s29 offen
    s_mov_b32 s29, 86016
    buffer_load_dword v20, v2, s[20:23], s29 offen
    s_mov_b32 s29, 93184
    buffer_load_dword v21, v2, s[20:23], s29 offen
    s_mov_b32 s29, 100352
    buffer_load_dword v22, v2, s[20:23], s29 offen
    s_mov_b32 s29, 107520
    buffer_load_dword v23, v2, s[20:23], s29 offen
    v_lshrrev_b32 v2, 3, v0
    v_lshlrev_b32 v2, 10, v2
    v_and_b32 v3, 7, v0
    v_lshl_add_u32 v2, v3, 4, v2
    s_mov_b32 s29, 0
    buffer_load_dwordx4 v[24:27], v2, s[16:19], s29 offen nt
    s_mov_b32 s29, 8192
    buffer_load_dwordx4 v[28:31], v2, s[16:19], s29 offen nt
    s_mov_b32 s29, 16384
    buffer_load_dwordx4 v[32:35], v2, s[16:19], s29 offen nt
    s_mov_b32 s29, 24576
    buffer_load_dwordx4 v[36:39], v2, s[16:19], s29 offen nt
    s_mov_b32 s29, 32768
    buffer_load_dwordx4 v[40:43], v2, s[16:19], s29 offen nt
    s_mov_b32 s29, 40960
    buffer_load_dwordx4 v[44:47], v2, s[16:19], s29 offen nt
    s_mov_b32 s29, 49152
    buffer_load_dwordx4 v[48:51], v2, s[16:19], s29 offen nt
    s_waitcnt vmcnt(7)
    v_add_f32 v5, v8, v10
    v_add_f32 v6, v9, v11
    v_add_f32 v5, v5, v12
    v_add_f32 v6, v6, v13
    v_add_f32 v5, v5, v14
    v_add_f32 v6, v6, v15
    v_add_f32 v5, v5, v16
    v_add_f32 v6, v6, v17
    v_add_f32 v5, v5, v18
    v_add_f32 v6, v6, v19
    v_add_f32 v5, v5, v20
    v_add_f32 v6, v6, v21
    v_add_f32 v5, v5, v22
    v_add_f32 v6, v6, v23
    v_cvt_pk_bf16_f32 v2, v5, v5
    v_lshlrev_b32 v5, 16, v2
    v_cvt_pk_bf16_f32 v2, v6, v6
    v_lshlrev_b32 v6, 16, v2
    v_mul_f32 v2, v5, v5
    v_mul_f32 v2, v2, v5
    v_mov_b32 v3, 0x3d372713
    v_fma_f32 v2, v2, v3, v5
    v_mul_f32 v2, 0x3f4c422a, v2
    v_mul_f32 v2, 0x4038aa3b, v2
    v_exp_f32 v2, v2
    s_nop 0
    v_add_f32 v2, 1.0, v2
    v_rcp_f32 v3, v2
    s_nop 0
    v_fma_f32 v4, -v2, v3, 1.0
    v_fma_f32 v3, v4, v3, v3
    v_fma_f32 v3, v3, -2.0, 1.0
    v_add_f32 v3, 1.0, v3
    v_mul_f32 v2, 0.5, v5
    v_mul_f32 v2, v2, v3
    v_cvt_pk_bf16_f32 v3, v2, v2
    v_lshlrev_b32 v2, 16, v3
    v_mul_f32 v5, v2, v6
    v_cvt_pk_bf16_f32 v3, v5, v5
    v_lshlrev_b32 v5, 16, v3
    v_lshlrev_b32 v2, 2, v0
    ds_write_b32 v2, v5 offset:0
    v_lshrrev_b32 v2, 3, v0
    v_lshlrev_b32 v2, 2, v2
    s_waitcnt lgkmcnt(0)
    ds_read_b32 v52, v2 offset:0
    ds_read_b32 v53, v2 offset:32
    ds_read_b32 v54, v2 offset:64
    ds_read_b32 v55, v2 offset:96
    ds_read_b32 v56, v2 offset:128
    ds_read_b32 v57, v2 offset:160
    ds_read_b32 v58, v2 offset:192
    s_waitcnt vmcnt(0) lgkmcnt(0)
    v_lshlrev_b32 v3, 16, v24
    v_and_b32 v4, 0xffff0000, v24
    v_mul_f32 v60, v52, v3
    v_mul_f32 v61, v52, v4
    v_lshlrev_b32 v3, 16, v25
    v_and_b32 v4, 0xffff0000, v25
    v_mul_f32 v62, v52, v3
    v_mul_f32 v63, v52, v4
    v_lshlrev_b32 v3, 16, v26
    v_and_b32 v4, 0xffff0000, v26
    v_mul_f32 v64, v52, v3
    v_mul_f32 v65, v52, v4
    v_lshlrev_b32 v3, 16, v27
    v_and_b32 v4, 0xffff0000, v27
    v_mul_f32 v66, v52, v3
    v_mul_f32 v67, v52, v4
    v_lshlrev_b32 v3, 16, v28
    v_and_b32 v4, 0xffff0000, v28
    v_fmac_f32 v60, v53, v3
    v_fmac_f32 v61, v53, v4
    v_lshlrev_b32 v3, 16, v29
    v_and_b32 v4, 0xffff0000, v29
    v_fmac_f32 v62, v53, v3
    v_fmac_f32 v63, v53, v4
    v_lshlrev_b32 v3, 16, v30
    v_and_b32 v4, 0xffff0000, v30
    v_fmac_f32 v64, v53, v3
    v_fmac_f32 v65, v53, v4
    v_lshlrev_b32 v3, 16, v31
    v_and_b32 v4, 0xffff0000, v31
    v_fmac_f32 v66, v53, v3
    v_fmac_f32 v67, v53, v4
    v_lshlrev_b32 v3, 16, v32
    v_and_b32 v4, 0xffff0000, v32
    v_fmac_f32 v60, v54, v3
    v_fmac_f32 v61, v54, v4
    v_lshlrev_b32 v3, 16, v33
    v_and_b32 v4, 0xffff0000, v33
    v_fmac_f32 v62, v54, v3
    v_fmac_f32 v63, v54, v4
    v_lshlrev_b32 v3, 16, v34
    v_and_b32 v4, 0xffff0000, v34
    v_fmac_f32 v64, v54, v3
    v_fmac_f32 v65, v54, v4
    v_lshlrev_b32 v3, 16, v35
    v_and_b32 v4, 0xffff0000, v35
    v_fmac_f32 v66, v54, v3
    v_fmac_f32 v67, v54, v4
    v_lshlrev_b32 v3, 16, v36
    v_and_b32 v4, 0xffff0000, v36
    v_fmac_f32 v60, v55, v3
    v_fmac_f32 v61, v55, v4
    v_lshlrev_b32 v3, 16, v37
    v_and_b32 v4, 0xffff0000, v37
    v_fmac_f32 v62, v55, v3
    v_fmac_f32 v63, v55, v4
    v_lshlrev_b32 v3, 16, v38
    v_and_b32 v4, 0xffff0000, v38
    v_fmac_f32 v64, v55, v3
    v_fmac_f32 v65, v55, v4
    v_lshlrev_b32 v3, 16, v39
    v_and_b32 v4, 0xffff0000, v39
    v_fmac_f32 v66, v55, v3
    v_fmac_f32 v67, v55, v4
    v_lshlrev_b32 v3, 16, v40
    v_and_b32 v4, 0xffff0000, v40
    v_fmac_f32 v60, v56, v3
    v_fmac_f32 v61, v56, v4
    v_lshlrev_b32 v3, 16, v41
    v_and_b32 v4, 0xffff0000, v41
    v_fmac_f32 v62, v56, v3
    v_fmac_f32 v63, v56, v4
    v_lshlrev_b32 v3, 16, v42
    v_and_b32 v4, 0xffff0000, v42
    v_fmac_f32 v64, v56, v3
    v_fmac_f32 v65, v56, v4
    v_lshlrev_b32 v3, 16, v43
    v_and_b32 v4, 0xffff0000, v43
    v_fmac_f32 v66, v56, v3
    v_fmac_f32 v67, v56, v4
    v_lshlrev_b32 v3, 16, v44
    v_and_b32 v4, 0xffff0000, v44
    v_fmac_f32 v60, v57, v3
    v_fmac_f32 v61, v57, v4
    v_lshlrev_b32 v3, 16, v45
    v_and_b32 v4, 0xffff0000, v45
    v_fmac_f32 v62, v57, v3
    v_fmac_f32 v63, v57, v4
    v_lshlrev_b32 v3, 16, v46
    v_and_b32 v4, 0xffff0000, v46
    v_fmac_f32 v64, v57, v3
    v_fmac_f32 v65, v57, v4
    v_lshlrev_b32 v3, 16, v47
    v_and_b32 v4, 0xffff0000, v47
    v_fmac_f32 v66, v57, v3
    v_fmac_f32 v67, v57, v4
    v_lshlrev_b32 v3, 16, v48
    v_and_b32 v4, 0xffff0000, v48
    v_fmac_f32 v60, v58, v3
    v_fmac_f32 v61, v58, v4
    v_lshlrev_b32 v3, 16, v49
    v_and_b32 v4, 0xffff0000, v49
    v_fmac_f32 v62, v58, v3
    v_fmac_f32 v63, v58, v4
    v_lshlrev_b32 v3, 16, v50
    v_and_b32 v4, 0xffff0000, v50
    v_fmac_f32 v64, v58, v3
    v_fmac_f32 v65, v58, v4
    v_lshlrev_b32 v3, 16, v51
    v_and_b32 v4, 0xffff0000, v51
    v_fmac_f32 v66, v58, v3
    v_fmac_f32 v67, v58, v4
    s_nop 1
    v_add_f32_dpp v60, v60, v60 row_ror:8 row_mask:0xf bank_mask:0xf
    v_add_f32_dpp v61, v61, v61 row_ror:8 row_mask:0xf bank_mask:0xf
    v_add_f32_dpp v62, v62, v62 row_ror:8 row_mask:0xf bank_mask:0xf
    v_add_f32_dpp v63, v63, v63 row_ror:8 row_mask:0xf bank_mask:0xf
    v_add_f32_dpp v64, v64, v64 row_ror:8 row_mask:0xf bank_mask:0xf
    v_add_f32_dpp v65, v65, v65 row_ror:8 row_mask:0xf bank_mask:0xf
    v_add_f32_dpp v66, v66, v66 row_ror:8 row_mask:0xf bank_mask:0xf
    v_add_f32_dpp v67, v67, v67 row_ror:8 row_mask:0xf bank_mask:0xf
    v_lshrrev_b32 v2, 4, v0
    v_lshlrev_b32 v2, 8, v2
    v_and_b32 v3, 7, v0
    v_lshl_add_u32 v2, v3, 5, v2
    s_mov_b32 s30, 0x00ff00ff
    s_mov_b32 s31, 0x00ff00ff
    s_mov_b64 exec, s[30:31]
    ds_write_b128 v2, v[60:63] offset:256
    ds_write_b128 v2, v[64:67] offset:272
    s_mov_b64 exec, -1
    v_lshlrev_b32 v2, 2, v0
    s_waitcnt lgkmcnt(0)
    ds_read_b32 v8, v2 offset:256
    ds_read_b32 v9, v2 offset:512
    ds_read_b32 v10, v2 offset:768
    ds_read_b32 v11, v2 offset:1024
    s_waitcnt lgkmcnt(0)
    v_add_f32 v3, v8, v9
    v_add_f32 v4, v10, v11
    v_add_f32 v3, v3, v4
    buffer_store_dword v3, v2, s[24:27], 0 offen
D_done:
    s_endpgm

.globl final_kernel
.p2align 8
.type final_kernel,@function
final_kernel:
    s_cmp_ge_u32 s2, 8
    s_cbranch_scc1 F_done
    s_load_dwordx2 s[4:5], s[0:1], 72
    s_load_dwordx2 s[6:7], s[0:1], 88
    s_waitcnt lgkmcnt(0)
    s_lshl_b32 s28, s2, 8
    s_add_u32 s28, s28, 4194304
    s_add_u32 s16, s6, s28
    s_addc_u32 s17, s7, 0
    s_mov_b32 s18, 63744
    s_mov_b32 s19, 0x00020000
    s_lshl_b32 s28, s2, 8
    s_add_u32 s28, s28, 2097152
    s_add_u32 s20, s6, s28
    s_addc_u32 s21, s7, 0
    s_mov_b32 s22, 256
    s_mov_b32 s23, 0x00020000
    s_lshl_b32 s28, s2, 7
    s_add_u32 s24, s4, s28
    s_addc_u32 s25, s5, 0
    s_mov_b32 s26, 128
    s_mov_b32 s27, 0x00020000
    v_lshlrev_b32 v2, 2, v0
    buffer_load_dword v4, v2, s[20:23], 0 offen
    s_mov_b32 s29, 0
    buffer_load_dword v8, v2, s[16:19], s29 offen offset:0
    buffer_load_dword v9, v2, s[16:19], s29 offen offset:2048
    s_mov_b32 s29, 4096
    buffer_load_dword v10, v2, s[16:19], s29 offen offset:0
    buffer_load_dword v11, v2, s[16:19], s29 offen offset:2048
    s_mov_b32 s29, 8192
    buffer_load_dword v12, v2, s[16:19], s29 offen offset:0
    buffer_load_dword v13, v2, s[16:19], s29 offen offset:2048
    s_mov_b32 s29, 12288
    buffer_load_dword v14, v2, s[16:19], s29 offen offset:0
    buffer_load_dword v15, v2, s[16:19], s29 offen offset:2048
    s_mov_b32 s29, 16384
    buffer_load_dword v16, v2, s[16:19], s29 offen offset:0
    buffer_load_dword v17, v2, s[16:19], s29 offen offset:2048
    s_mov_b32 s29, 20480
    buffer_load_dword v18, v2, s[16:19], s29 offen offset:0
    buffer_load_dword v19, v2, s[16:19], s29 offen offset:2048
    s_mov_b32 s29, 24576
    buffer_load_dword v20, v2, s[16:19], s29 offen offset:0
    buffer_load_dword v21, v2, s[16:19], s29 offen offset:2048
    s_mov_b32 s29, 28672
    buffer_load_dword v22, v2, s[16:19], s29 offen offset:0
    buffer_load_dword v23, v2, s[16:19], s29 offen offset:2048
    s_mov_b32 s29, 32768
    buffer_load_dword v24, v2, s[16:19], s29 offen offset:0
    buffer_load_dword v25, v2, s[16:19], s29 offen offset:2048
    s_mov_b32 s29, 36864
    buffer_load_dword v26, v2, s[16:19], s29 offen offset:0
    buffer_load_dword v27, v2, s[16:19], s29 offen offset:2048
    s_mov_b32 s29, 40960
    buffer_load_dword v28, v2, s[16:19], s29 offen offset:0
    buffer_load_dword v29, v2, s[16:19], s29 offen offset:2048
    s_mov_b32 s29, 45056
    buffer_load_dword v30, v2, s[16:19], s29 offen offset:0
    buffer_load_dword v31, v2, s[16:19], s29 offen offset:2048
    s_mov_b32 s29, 49152
    buffer_load_dword v32, v2, s[16:19], s29 offen offset:0
    buffer_load_dword v33, v2, s[16:19], s29 offen offset:2048
    s_mov_b32 s29, 53248
    buffer_load_dword v34, v2, s[16:19], s29 offen offset:0
    buffer_load_dword v35, v2, s[16:19], s29 offen offset:2048
    s_mov_b32 s29, 57344
    buffer_load_dword v36, v2, s[16:19], s29 offen offset:0
    buffer_load_dword v37, v2, s[16:19], s29 offen offset:2048
    s_mov_b32 s29, 61440
    buffer_load_dword v38, v2, s[16:19], s29 offen offset:0
    buffer_load_dword v39, v2, s[16:19], s29 offen offset:2048
    s_waitcnt vmcnt(0)
    v_add_f32 v3, v8, v9
    v_add_f32 v3, v3, v10
    v_add_f32 v3, v3, v11
    v_add_f32 v3, v3, v12
    v_add_f32 v3, v3, v13
    v_add_f32 v3, v3, v14
    v_add_f32 v3, v3, v15
    v_add_f32 v3, v3, v16
    v_add_f32 v3, v3, v17
    v_add_f32 v3, v3, v18
    v_add_f32 v3, v3, v19
    v_add_f32 v3, v3, v20
    v_add_f32 v3, v3, v21
    v_add_f32 v3, v3, v22
    v_add_f32 v3, v3, v23
    v_add_f32 v3, v3, v24
    v_add_f32 v3, v3, v25
    v_add_f32 v3, v3, v26
    v_add_f32 v3, v3, v27
    v_add_f32 v3, v3, v28
    v_add_f32 v3, v3, v29
    v_add_f32 v3, v3, v30
    v_add_f32 v3, v3, v31
    v_add_f32 v3, v3, v32
    v_add_f32 v3, v3, v33
    v_add_f32 v3, v3, v34
    v_add_f32 v3, v3, v35
    v_add_f32 v3, v3, v36
    v_add_f32 v3, v3, v37
    v_add_f32 v3, v3, v38
    v_add_f32 v3, v3, v39
    v_cvt_pk_bf16_f32 v2, v3, v3
    v_lshlrev_b32 v3, 16, v2
    v_add_f32 v3, v4, v3
    v_cvt_pk_bf16_f32 v3, v3, v3
    v_lshlrev_b32 v2, 1, v0
    buffer_store_short v3, v2, s[24:27], 0 offen
F_done:
    s_endpgm

.section .rodata,"a"
.p2align 6
.amdhsa_kernel attn_kernel
  .amdhsa_next_free_vgpr 124
  .amdhsa_next_free_sgpr 102
  .amdhsa_accum_offset 124
  .amdhsa_group_segment_fixed_size 0
  .amdhsa_kernarg_size 96
  .amdhsa_user_sgpr_count 2
  .amdhsa_user_sgpr_kernarg_segment_ptr 1
  .amdhsa_system_sgpr_workgroup_id_x 1
.end_amdhsa_kernel

.p2align 6
.amdhsa_kernel wo_kernel
  .amdhsa_next_free_vgpr 60
  .amdhsa_next_free_sgpr 102
  .amdhsa_accum_offset 60
  .amdhsa_group_segment_fixed_size 0
  .amdhsa_kernarg_size 96
  .amdhsa_user_sgpr_count 2
  .amdhsa_user_sgpr_kernarg_segment_ptr 1
  .amdhsa_system_sgpr_workgroup_id_x 1
.end_amdhsa_kernel

.p2align 6
.amdhsa_kernel geglu_kernel
  .amdhsa_next_free_vgpr 108
  .amdhsa_next_free_sgpr 102
  .amdhsa_accum_offset 108
  .amdhsa_group_segment_fixed_size 0
  .amdhsa_kernarg_size 96
  .amdhsa_user_sgpr_count 2
  .amdhsa_user_sgpr_kernarg_segment_ptr 1
  .amdhsa_system_sgpr_workgroup_id_x 1
.end_amdhsa_kernel

.p2align 6
.amdhsa_kernel down_kernel
  .amdhsa_next_free_vgpr 68
  .amdhsa_next_free_sgpr 102
  .amdhsa_accum_offset 68
  .amdhsa_group_segment_fixed_size 0
  .amdhsa_kernarg_size 96
  .amdhsa_user_sgpr_count 2
  .amdhsa_user_sgpr_kernarg_segment_ptr 1
  .amdhsa_system_sgpr_workgroup_id_x 1
.end_amdhsa_kernel

.p2align 6
.amdhsa_kernel final_kernel
  .amdhsa_next_free_vgpr 40
  .amdhsa_next_free_sgpr 102
  .amdhsa_accum_offset 40
  .amdhsa_group_segment_fixed_size 0
  .amdhsa_kernarg_size 96
  .amdhsa_user_sgpr_count 2
  .amdhsa_user_sgpr_kernarg_segment_ptr 1
  .amdhsa_system_sgpr_workgroup_id_x 1
.end_amdhsa_kernel
```
